```python
import torch

def _softmax(x, axis=-1):
    return torch.softmax(x, dim=axis)
def _gelu(x):
    return torch.nn.functional.gelu(x, approximate="tanh")
def _silu(x):
    return torch.nn.functional.silu(x)
def _sigmoid(x):
    return torch.sigmoid(x)
def _layernorm(x, axis=-1, eps=1e-5):
    m = x.mean(dim=axis, keepdim=True)
    v = x.var(dim=axis, keepdim=True, unbiased=False)
    return (x - m) / torch.sqrt(v + eps)
def _scatter_add(tgt, idx, src, axis=0):
    return tgt.clone().index_add_(axis, idx, src)
def _segment_sum(src, seg, n):
    out = torch.zeros((n,) + src.shape[1:], dtype=src.dtype)
    return out.index_add_(0, seg, src)
def _pad(x, pw):
    flat = tuple(v for pair in reversed(pw) for v in pair)
    return torch.nn.functional.pad(x, flat)

kernel_name = 'parallel_sum__ssm_conv_h3__glu_gated_bilinear__prompt'

def setup_inputs():

    _w = (lambda a: (lambda t: t.to(torch.bfloat16) if t.is_floating_point() else t)(torch.as_tensor(a)))
    def _A_setup():
        B, S, D = 1, 2048, 448
        ks = 4
        return {
            "q": _w((lambda *s: torch.randn(*s, dtype=torch.bfloat16) * 0.05)(B, S, D)),
            "k": _w((lambda *s: torch.randn(*s, dtype=torch.bfloat16) * 0.2)(B, S, D)),
            "v": _w((lambda *s: torch.randn(*s, dtype=torch.bfloat16) * 0.2)(B, S, D)),
            "shift_k": _w((lambda *s: torch.randn(*s, dtype=torch.bfloat16) * 0.2)(D, ks) * 0.5),
            "ssm_k": _w((lambda *s: torch.randn(*s, dtype=torch.bfloat16) * 0.4)(D, S) * (1.0 / S ** 0.5)),
            "ssm_D": _w((lambda *s: torch.randn(*s, dtype=torch.bfloat16) * 0.2)(D)),
        }
    _A_in = _A_setup()

    def _B_setup():
        B, S, D, F = 1, 2048, 448, 1792
        return {
            "x": _w((lambda *s: torch.randn(*s, dtype=torch.bfloat16) * 0.05)(B, S, D)),
            "w_gate": _w((lambda *s: torch.randn(*s, dtype=torch.bfloat16) * 0.2)(D, F) * (D ** -0.5)),
            "w_up": _w((lambda *s: torch.randn(*s, dtype=torch.bfloat16) * 0.2)(D, F) * (D ** -0.5)),
            "w_down": _w((lambda *s: torch.randn(*s, dtype=torch.bfloat16) * 0.2)(F, D) * (F ** -0.5)),
        }
    _B_in = _B_setup()

    return {
        "A_q": _A_in["q"],
        "A_k": _A_in["k"],
        "A_v": _A_in["v"],
        "A_shift_k": _A_in["shift_k"],
        "A_ssm_k": _A_in["ssm_k"],
        "A_ssm_D": _A_in["ssm_D"],
        "B_x": _B_in["x"],
        "B_w_gate": _B_in["w_gate"],
        "B_w_up": _B_in["w_up"],
        "B_w_down": _B_in["w_down"],
    }

def reference(A_q, A_k, A_v, A_shift_k, A_ssm_k, A_ssm_D, B_x, B_w_gate, B_w_up, B_w_down):
    def _A_ref(q, k, v, shift_k, ssm_k, ssm_D):
        B, S, D = q.shape
        ks = shift_k.shape[-1]
        k_pad = _pad(k, ((0, 0), (ks - 1, 0), (0, 0)))
        k_shift = torch.zeros_like(k)
        for t in range(ks):
            k_shift = k_shift + k_pad[:, t:t + S, :] * shift_k[:, ks - 1 - t][None, None, :]
        kv = k_shift * v
        L = 2 * S
        kv_pad = _pad(kv, ((0, 0), (0, S), (0, 0)))
        kf_pad = _pad(ssm_k, ((0, 0), (0, S)))
        kv_f = (lambda x, axes=(-2,-1): torch.fft.rfft2(x.float(), dim=axes))(kv_pad[:, None, :, :], axes=(1, 2))
        kf_f = (lambda x, axes=(-2,-1): torch.fft.rfft2(x.float(), dim=axes))(kf_pad[:, None, :], axes=(1, 2))
        kf_f = (lambda x, *d: x.permute(*d))(kf_f, 1, 2, 0)
        y_f = kv_f * kf_f[None, :, :, :]
        y = (lambda x, s, axes=(-2,-1): torch.fft.irfft2(x, s=s, dim=axes).to(torch.bfloat16))(y_f, (1, L), axes=(1, 2))[:, 0, :S, :]
        y = y + kv * ssm_D[None, None, :]
        return q * y

    def _B_ref(x, w_gate, w_up, w_down):
        g = torch.einsum("bsd,df->bsf", x, w_gate)
        u = torch.einsum("bsd,df->bsf", x, w_up)
        h = g * u
        return torch.einsum("bsf,fd->bsd", h, w_down)

    x = A_q
    xn = _layernorm(x, axis=-1)
    return x + _A_ref(xn, A_k, A_v, A_shift_k, A_ssm_k, A_ssm_D) + _B_ref(xn, B_w_gate, B_w_up, B_w_down)
```

```asm
; @launch grid=(256,1,1) block=(256,1,1) lds=163840
.amdgcn_target "amdgcn-amd-amdhsa--gfx950"
.text
.globl parallel_sum__ssm_conv_h3__glu_gated_bilinear__prompt_kernel
.p2align 8
.type parallel_sum__ssm_conv_h3__glu_gated_bilinear__prompt_kernel,@function
parallel_sum__ssm_conv_h3__glu_gated_bilinear__prompt_kernel:
    s_cmp_ge_u32 s2, 256
    s_cbranch_scc1 L_exit
    s_load_dwordx16 s[4:19], s[0:1], 0
    s_load_dwordx8 s[20:27], s[0:1], 64
    s_load_dwordx2 s[28:29], s[0:1], 96
    v_and_b32 v1, 63, v0
    v_lshrrev_b32 v60, 6, v0
    v_lshlrev_b32 v30, 4, v1
    v_readfirstlane_b32 s72, v60
    v_cmp_eq_u32 vcc, 0, v1
    v_mov_b32 v61, 0x80000000
    v_mov_b32 v62, 0
    v_cndmask_b32 v31, v61, v62, vcc
    s_cmp_lt_u32 s2, 32
    s_cbranch_scc1 L_helper
L_main:
    s_sub_u32 s77, s2, 32
    s_and_b32 s90, s2, 7
    s_lshr_b32 s91, s77, 3
    s_lshr_b32 s76, s91, 2
    s_and_b32 s91, s91, 3
    s_lshl_b32 s75, s90, 2
    s_add_u32 s75, s75, s91
    s_lshr_b32 s73, s90, 1
    s_lshl_b32 s73, s73, 2
    s_add_u32 s73, s73, s91
    s_and_b32 s31, s90, 1
    s_mul_i32 s74, s31, 7
    s_add_u32 s74, s74, s76
    s_and_b32 s79, s72, 1
    s_lshr_b32 s80, s72, 1
    s_lshl_b32 s81, s72, 12
    s_add_u32 s82, s81, 98560
    s_add_u32 s90, s76, 1
    s_sub_u32 s92, s90, 7
    s_min_u32 s90, s90, s92
    s_mul_i32 s83, s90, 229376
    s_lshl_b32 s84, s90, 7
    s_add_u32 s87, s83, 128
    v_lshrrev_b32 v60, 4, v1
    s_mul_i32 s90, s79, 114688
    s_lshl_b32 s91, s74, 8
    s_add_u32 s90, s90, s91
    v_lshrrev_b32 v61, 3, v1
    v_mul_u32_u24 v61, 3584, v61
    s_lshl_b32 s91, s80, 2
    v_and_b32 v62, 1, v60
    v_lshlrev_b32 v62, 1, v62
    v_or_b32 v62, s91, v62
    v_and_b32 v63, 7, v1
    v_xor_b32 v62, v62, v63
    v_lshlrev_b32 v62, 4, v62
    v_add3_u32 v14, v61, v62, s90
    v_add_u32 v15, 27648, v14
    v_add_u32 v16, 55296, v14
    v_add_u32 v17, 82944, v14
    s_lshl_b32 s90, s73, 2
    s_add_u32 s90, s90, s72
    s_xor_b32 s90, s90, s31
    s_xor_b32 s90, s90, 1
    s_mul_i32 s90, s90, 28672
    v_lshrrev_b32 v61, 3, v1
    v_mul_u32_u24 v61, 896, v61
    v_and_b32 v63, 7, v1
    v_xor_b32 v62, v63, v60
    v_lshlrev_b32 v62, 4, v62
    v_add3_u32 v18, v61, v62, s90
    v_xor_b32 v62, 64, v18
    v_add_u32 v19, 6144, v62
    v_add_u32 v20, 12288, v18
    v_add_u32 v21, 18432, v62
    s_waitcnt lgkmcnt(0)
    s_cmp_ge_u32 s72, 2
    s_cselect_b32 s56, s20, s18
    s_cselect_b32 s57, s21, s19
    s_mov_b32 s58, 1605632
    s_mov_b32 s59, 0x00020000
    s_mov_b32 s32, s4
    s_mov_b32 s33, s5
    s_mov_b32 s34, 1835008
    s_mov_b32 s35, 0x00020000
    s_add_u32 m0, s81, 0
    s_nop 0
    buffer_load_dwordx4 v14, s[56:59], s83 offen offset:0  lds
    buffer_load_dwordx4 v15, s[56:59], s83 offen offset:1024  lds
    buffer_load_dwordx4 v16, s[56:59], s83 offen offset:2048  lds
    buffer_load_dwordx4 v17, s[56:59], s83 offen offset:3072  lds
    s_add_u32 s83, s83, 229376
    s_cmp_eq_u32 s83, 1605632
    s_cselect_b32 s83, 0, s83
    s_add_u32 m0, s82, 0
    s_nop 0
    buffer_load_dwordx4 v18, s[32:35], s84 offen offset:0  lds
    buffer_load_dwordx4 v19, s[32:35], s84 offen offset:1024  lds
    buffer_load_dwordx4 v20, s[32:35], s84 offen offset:2048  lds
    buffer_load_dwordx4 v21, s[32:35], s84 offen offset:3072  lds
    s_add_u32 s84, s84, 128
    s_cmp_eq_u32 s84, 896
    s_cselect_b32 s84, 0, s84
    s_add_u32 m0, s81, 16384
    s_nop 0
    buffer_load_dwordx4 v14, s[56:59], s83 offen offset:0  lds
    buffer_load_dwordx4 v15, s[56:59], s83 offen offset:1024  lds
    buffer_load_dwordx4 v16, s[56:59], s83 offen offset:2048  lds
    buffer_load_dwordx4 v17, s[56:59], s83 offen offset:3072  lds
    s_add_u32 s83, s83, 229376
    s_cmp_eq_u32 s83, 1605632
    s_cselect_b32 s83, 0, s83
    s_mov_b32 s36, s6
    s_mov_b32 s37, s7
    s_mov_b32 s38, 1835008
    s_mov_b32 s39, 0x00020000
    s_mov_b32 s40, s8
    s_mov_b32 s41, s9
    s_mov_b32 s42, 1835008
    s_mov_b32 s43, 0x00020000
    s_mov_b32 s44, s10
    s_mov_b32 s45, s11
    s_mov_b32 s46, 3584
    s_mov_b32 s47, 0x00020000
    s_mov_b32 s48, s12
    s_mov_b32 s49, s13
    s_mov_b32 s50, 1835008
    s_mov_b32 s51, 0x00020000
    s_mov_b32 s52, s14
    s_mov_b32 s53, s15
    s_mov_b32 s54, 896
    s_mov_b32 s55, 0x00020000
    s_mov_b32 s60, s22
    s_mov_b32 s61, s23
    s_mov_b32 s62, 1605632
    s_mov_b32 s63, 0x00020000
    s_mov_b32 s64, s24
    s_mov_b32 s65, s25
    s_mov_b32 s66, 1835008
    s_mov_b32 s67, 0x00020000
    s_mov_b32 s68, s28
    s_mov_b32 s69, s29
    s_mov_b32 s70, 19398656
    s_mov_b32 s71, 0x00020000
    s_mov_b32 s90, 13336576
    v_mov_b32 v64, 0
    buffer_load_dword v32, v64, s[68:71], s90 offen sc1
    s_mul_i32 s90, s31, 802816
    s_lshl_b32 s91, s76, 7
    s_add_u32 s90, s90, s91
    s_mul_i32 s91, s72, 28672
    s_add_u32 s90, s90, s91
    v_and_b32 v62, 1, v60
    v_lshlrev_b32 v62, 2, v62
    v_xor_b32 v62, v62, v63
    v_lshlrev_b32 v62, 4, v62
    v_add3_u32 v22, v61, v62, s90
    v_add_u32 v23, 6144, v22
    v_add_u32 v24, 12288, v22
    v_add_u32 v25, 18432, v22
    v_bfe_u32 v60, v1, 2, 2
    v_bfe_u32 v61, v1, 4, 1
    v_lshrrev_b32 v62, 5, v1
    v_and_b32 v63, 3, v1
    v_lshlrev_b32 v63, 3, v63
    v_lshl_add_u32 v64, v62, 3, v60
    v_lshlrev_b32 v64, 7, v64
    v_lshl_add_u32 v64, v61, 13, v64
    v_add_u32 v64, v64, v63
    v_lshrrev_b32 v65, 1, v60
    v_lshl_or_b32 v65, v61, 1, v65
    s_lshl_b32 s90, s79, 1
    v_xor_b32 v65, s90, v65
    v_xor_b32 v2, 0, v65
    v_lshl_add_u32 v2, v2, 5, v64
    v_add_u32 v6, 49152, v2
    v_xor_b32 v3, 1, v65
    v_lshl_add_u32 v3, v3, 5, v64
    v_add_u32 v7, 49152, v3
    v_lshl_add_u32 v64, v62, 2, v60
    v_lshlrev_b32 v64, 7, v64
    s_lshl_b32 s90, s79, 12
    v_lshl_add_u32 v64, v61, 5, v64
    v_add3_u32 v64, v64, v63, s90
    v_lshrrev_b32 v65, 1, v60
    v_xor_b32 v65, s79, v65
    v_lshl_add_u32 v26, v65, 6, v64
    v_xor_b32 v27, 64, v26
    v_add_u32 v28, 0x10000, v26
    v_add_u32 v29, 0x10000, v27
    v_and_b32 v66, 31, v1
    v_bfe_u32 v61, v1, 1, 3
    v_xor_b32 v61, v61, v62
    s_lshl_b32 s90, s80, 13
    s_add_u32 s90, s90, 98560
    v_lshlrev_b32 v60, 7, v66
    v_add_u32 v60, s90, v60
    v_xor_b32 v10, 0, v61
    v_lshl_add_u32 v10, v10, 4, v60
    v_xor_b32 v11, 2, v61
    v_lshl_add_u32 v11, v11, 4, v60
    v_xor_b32 v12, 4, v61
    v_lshl_add_u32 v12, v12, 4, v60
    v_xor_b32 v13, 6, v61
    v_lshl_add_u32 v13, v13, 4, v60
    s_lshl_b32 s90, s75, 2
    s_add_u32 s90, s90, s72
    s_mul_i32 s92, s90, 14336
    s_lshl_b32 s91, s76, 7
    s_add_u32 s30, s92, s91
    s_add_u32 s95, s30, 6144
    s_sub_u32 s96, s30, 7168
    s_cmp_eq_u32 s90, 0
    s_cselect_b32 s96, 0x40000000, s96
    v_lshrrev_b32 v60, 3, v1
    v_mul_u32_u24 v71, 896, v60
    v_and_b32 v61, 7, v1
    v_lshl_add_u32 v71, v61, 4, v71
    v_cmp_gt_u32 vcc, 40, v1
    v_mov_b32 v60, 0x80000000
    s_lshr_b32 s94, s81, 2
    v_cndmask_b32 v73, v71, v60, vcc
    s_lshl_b32 s93, s76, 9
    v_lshlrev_b32 v72, 4, v66
    s_add_u32 s90, s81, 81920
    v_lshl_add_u32 v60, v66, 2, s90
    v_lshl_add_u32 v68, v62, 10, v60
    v_add_u32 v69, 2048, v68
    s_add_u32 s90, s94, 157440
    v_lshl_add_u32 v61, v66, 2, s90
    v_cmp_gt_u32 vcc, 32, v1
    s_nop 1
    v_cndmask_b32 v70, v60, v61, vcc
    v_add_u32 v70, 640, v70
    s_lshl_b32 s15, s77, 1
    s_add_u32 s15, s15, s80
    s_lshl_b32 s15, s15, 12
    v_and_b32 v67, 15, v1
    s_lshl_b32 s7, s76, 18
    s_lshl_b32 s90, s75, 7
    s_sub_u32 s7, s7, s90
    s_add_u32 s7, s7, 7344000
    s_add_u32 s8, s7, 131072
    s_lshl_b32 s90, s76, 5
    s_add_u32 s90, s90, s75
    s_lshl_b32 s90, s90, 7
    s_add_u32 s90, s90, 13107200
    s_cmp_eq_u32 s72, 0
    s_cselect_b32 s9, s90, 0x40000000
    s_lshl_b32 s90, s72, 1
    s_sub_u32 s90, 7, s90
    v_sub_u32 v60, s90, v62
    v_and_b32 v61, 7, v1
    v_xor_b32 v60, v60, v61
    v_lshlrev_b32 v60, 4, v60
    v_lshl_add_u32 v60, v67, 8, v60
    v_lshrrev_b32 v63, 4, v66
    v_mul_u32_u24 v63, 4608, v63
    v_add_u32 v60, v60, v63
    v_add_u32 v60, 148224, v60
    v_accvgpr_write_b32 a226, v60
    v_lshrrev_b32 v60, 3, v0
    v_bfe_u32 v63, v0, 4, 3
    v_xor_b32 v63, v63, v61
    v_lshlrev_b32 v63, 4, v63
    v_lshl_add_u32 v63, v60, 7, v63
    v_add_u32 v63, 148224, v63
    v_accvgpr_write_b32 a227, v63
    v_lshlrev_b32 v60, 12, v60
    v_lshl_add_u32 v60, v61, 4, v60
    v_accvgpr_write_b32 a228, v60
    v_lshrrev_b32 v90, 5, v1
    v_lshrrev_b32 v93, 4, v1
    v_and_b32 v94, 31, v1
    v_and_b32 v95, 15, v1
    s_mov_b32 s90, s76
    s_mul_i32 s85, s90, 114688
    s_lshl_b32 s20, s90, 13
    s_lshl_b32 s90, s73, 1
    s_add_u32 s90, s90, s80
    s_lshl_b32 s91, s74, 1
    s_add_u32 s91, s91, s79
    s_lshl_b32 s13, s90, 9
    s_add_u32 s13, s13, 12845056
    s_lshl_b32 s92, s31, 8
    s_add_u32 s29, s13, s92
    s_xor_b32 s13, s29, 256
    s_lshl_b32 s12, s74, 2
    s_add_u32 s12, s12, s79
    s_lshl_b32 s12, s12, 10
    s_add_u32 s12, s12, 12861440
    s_mul_i32 s4, s90, 224
    s_lshl_b32 s92, s91, 2
    s_add_u32 s4, s4, s92
    s_lshl_b32 s5, s4, 10
    s_add_u32 s4, s5, 114688
    s_mul_i32 s92, s31, 114688
    s_sub_u32 s4, s4, s92
    s_add_u32 s5, s5, s92
    s_lshl_b32 s6, s90, 5
    s_add_u32 s6, s6, s91
    s_lshl_b32 s6, s6, 7
    s_add_u32 s6, s6, 12976128
    s_mov_b32 s27, 13107200
    s_and_b32 s90, s77, 0xffffffe0
    v_add_lshl_u32 v88, v94, s90, 7
    v_accvgpr_write_b32 a229, v88
    s_lshl_b32 s10, s77, 13
    s_add_u32 s10, s10, 7340032
    s_add_u32 s11, s10, 4096
    s_mul_i32 s14, s80, 16640
    s_add_u32 s14, s14, 114944
    v_lshrrev_b32 v91, 7, v0
    v_mul_u32_u24 v91, 4608, v91
    v_and_b32 v92, 127, v0
    v_lshl_add_u32 v91, v92, 2, v91
    v_add_u32 v91, 152320, v91
    v_mov_b32 v92, 0
    ds_write_b32 v91, v92
    v_and_b32 v91, 3, v95
    v_mul_u32_u24 v91, 4160, v91
    v_lshrrev_b32 v88, 2, v95
    v_lshl_add_u32 v91, v88, 3, v91
    v_lshl_add_u32 v91, v93, 4, v91
    s_lshl_b32 s92, s79, 8
    s_add_u32 s92, s92, s14
    v_add_u32 v91, s92, v91
    v_accvgpr_write_b32 a230, v91
    v_mul_u32_u24 v91, 4160, v93
    v_lshl_add_u32 v91, v95, 2, v91
    v_add_u32 v91, s14, v91
    v_accvgpr_write_b32 a231, v91
    s_mul_i32 s90, s80, 4608
    s_add_u32 s90, s90, 148224
    s_lshl_b32 s92, s79, 8
    s_add_u32 s91, s90, s92
    s_add_u32 s91, s91, 480
    v_lshlrev_b32 v92, 5, v95
    v_sub_u32 v88, s91, v92
    v_lshl_add_u32 v88, v93, 4, v88
    v_accvgpr_write_b32 a232, v88
    s_lshl_b32 s92, s92, 3
    s_sub_u32 s91, s90, s92
    s_add_u32 s91, s91, 2552
    v_sub_u32 v88, s91, v92
    v_lshlrev_b32 v92, 3, v93
    v_sub_u32 v88, v88, v92
    v_accvgpr_write_b32 a233, v88
    v_lshlrev_b32 v88, 6, v95
    v_lshl_add_u32 v88, v93, 4, v88
    v_accvgpr_write_b32 a236, v88
    s_lshl_b32 s16, s15, 1
    s_lshl_b32 s90, s79, 12
    s_add_u32 s16, s16, s90
    s_add_u32 s16, s16, 9175040
    s_lshl_b32 s90, s73, 1
    s_add_u32 s90, s90, s80
    s_lshl_b32 s90, s90, 1
    s_add_u32 s90, s90, s31
    s_lshl_b32 s91, s76, 1
    s_add_u32 s91, s91, s79
    s_lshl_b32 s18, s91, 18
    s_lshl_b32 s92, s90, 7
    s_add_u32 s18, s18, s92
    s_add_u32 s18, s18, 9175040
    s_lshl_b32 s19, s90, 9
    s_add_u32 s19, s19, 12926976
    s_and_b32 s92, s90, 0xfffffffe
    s_mul_i32 s21, s92, 114688
    s_mul_i32 s26, s31, 114688
    s_sub_u32 s25, 114688, s26
    s_mul_i32 s90, s90, 28672
    s_lshl_b32 s92, s91, 6
    s_add_u32 s90, s90, s92
    v_mul_u32_u24 v88, 896, v94
    v_lshlrev_b32 v89, 4, v90
    v_add3_u32 v88, v88, v89, s90
    v_accvgpr_write_b32 a234, v88
    v_lshrrev_b32 v88, 2, v95
    v_lshl_add_u32 v88, v90, 3, v88
    v_lshlrev_b32 v88, 6, v88
    v_and_b32 v89, 1, v93
    v_lshl_add_u32 v88, v89, 5, v88
    v_and_b32 v89, 3, v95
    v_lshl_add_u32 v88, v89, 3, v88
    s_lshr_b32 s17, s81, 1
    s_add_u32 s17, s17, 16384
    v_add_u32 v88, s17, v88
    v_accvgpr_write_b32 a237, v88
    v_lshrrev_b32 v88, 3, v1
    v_lshlrev_b32 v88, 13, v88
    v_and_b32 v89, 7, v1
    v_lshl_add_u32 v88, v89, 4, v88
    v_accvgpr_write_b32 a238, v88
    v_lshlrev_b32 v88, 10, v90
    v_lshl_add_u32 v88, v94, 4, v88
    v_add_u32 v88, s81, v88
    v_accvgpr_write_b32 a239, v88
    s_lshl_b32 s90, s77, 2
    s_add_u32 s90, s90, s72
    s_mul_i32 s24, s90, 3072
    s_add_u32 s24, s24, 13631488
    s_xor_b32 s90, s90, 4
    s_mul_i32 s23, s90, 3072
    s_add_u32 s23, s23, 13631488
    s_mov_b32 s28, 12976128
    s_mul_i32 s91, s31, 14
    s_add_u32 s91, s91, s79
    s_lshl_b32 s92, s91, 12
    s_add_u32 s21, s21, s92
    s_add_u32 s22, s21, 57344
    s_add_u32 s20, s21, s20
    s_lshl_b32 s92, s73, 1
    s_add_u32 s92, s92, s80
    s_lshl_b32 s92, s92, 5
    s_add_u32 s90, s91, s92
    v_min_u32 v88, 6, v1
    v_lshlrev_b32 v88, 1, v88
    v_add_lshl_u32 v88, v88, s90, 7
    v_accvgpr_write_b32 a235, v88
    s_add_u32 m0, s82, 16640
    s_nop 0
    buffer_load_dwordx4 v18, s[32:35], s84 offen offset:0  lds
    buffer_load_dwordx4 v19, s[32:35], s84 offen offset:1024  lds
    buffer_load_dwordx4 v20, s[32:35], s84 offen offset:2048  lds
    buffer_load_dwordx4 v21, s[32:35], s84 offen offset:3072  lds
    s_add_u32 s84, s84, 128
    s_cmp_eq_u32 s84, 896
    s_cselect_b32 s84, 0, s84
    s_waitcnt vmcnt(9)
    s_barrier
    ds_read_b128 a[0:3], v10 offset:0
    ds_read_b128 a[4:7], v10 offset:4096
    ds_read_b64_tr_b16 v[96:97], v2 offset:0
    ds_read_b64_tr_b16 v[98:99], v2 offset:512
    ds_read_b64_tr_b16 v[100:101], v3 offset:0
    ds_read_b64_tr_b16 v[102:103], v3 offset:512
    s_waitcnt lgkmcnt(2)
    v_mfma_f32_32x32x16_bf16 v[128:143], v[96:99], a[0:3], 0
    ds_read_b128 a[8:11], v11 offset:0
    ds_read_b128 a[12:15], v11 offset:4096
    s_add_u32 m0, s82, 33280
    s_nop 0
    buffer_load_dwordx4 v18, s[32:35], s84 offen offset:0  lds
    s_nop 0
    v_mfma_f32_32x32x16_bf16 v[144:159], v[96:99], a[4:7], 0
    ds_read_b64_tr_b16 v[104:105], v2 offset:2048
    ds_read_b64_tr_b16 v[106:107], v2 offset:2560
    buffer_load_dwordx4 v19, s[32:35], s84 offen offset:1024  lds
    s_waitcnt lgkmcnt(4)
    v_mfma_f32_32x32x16_bf16 v[160:175], v[100:103], a[0:3], 0
    ds_read_b64_tr_b16 v[108:109], v3 offset:2048
    ds_read_b64_tr_b16 v[110:111], v3 offset:2560
    buffer_load_dwordx4 v20, s[32:35], s84 offen offset:2048  lds
    v_mfma_f32_32x32x16_bf16 v[176:191], v[100:103], a[4:7], 0
    ds_read_b128 a[16:19], v12 offset:0
    ds_read_b128 a[20:23], v12 offset:4096
    buffer_load_dwordx4 v21, s[32:35], s84 offen offset:3072  lds
    s_add_u32 s84, s84, 128
    s_waitcnt lgkmcnt(4)
    v_mfma_f32_32x32x16_bf16 v[128:143], v[104:107], a[8:11], v[128:143]
    ds_read_b64_tr_b16 v[112:113], v2 offset:4096
    ds_read_b64_tr_b16 v[114:115], v2 offset:4608
    s_cmp_eq_u32 s84, 896
    s_cselect_b32 s84, 0, s84
    s_add_u32 m0, s81, 32768
    v_mfma_f32_32x32x16_bf16 v[144:159], v[104:107], a[12:15], v[144:159]
    ds_read_b64_tr_b16 v[116:117], v3 offset:4096
    ds_read_b64_tr_b16 v[118:119], v3 offset:4608
    s_nop 0
    buffer_load_dwordx4 v14, s[56:59], s83 offen offset:0  lds
    s_waitcnt lgkmcnt(6)
    v_mfma_f32_32x32x16_bf16 v[160:175], v[108:111], a[8:11], v[160:175]
    ds_read_b128 a[24:27], v13 offset:0
    ds_read_b128 a[28:31], v13 offset:4096
    buffer_load_dwordx4 v15, s[56:59], s83 offen offset:1024  lds
    v_mfma_f32_32x32x16_bf16 v[176:191], v[108:111], a[12:15], v[176:191]
    ds_read_b64_tr_b16 v[120:121], v2 offset:6144
    ds_read_b64_tr_b16 v[122:123], v2 offset:6656
    buffer_load_dwordx4 v16, s[56:59], s83 offen offset:2048  lds
    s_waitcnt lgkmcnt(6)
    v_mfma_f32_32x32x16_bf16 v[128:143], v[112:115], a[16:19], v[128:143]
    ds_read_b64_tr_b16 v[124:125], v3 offset:6144
    ds_read_b64_tr_b16 v[126:127], v3 offset:6656
    buffer_load_dwordx4 v17, s[56:59], s83 offen offset:3072  lds
    s_add_u32 s83, s83, 229376
    s_cmp_eq_u32 s83, 1605632
    s_cselect_b32 s83, 0, s83
    v_mfma_f32_32x32x16_bf16 v[144:159], v[112:115], a[20:23], v[144:159]
    s_waitcnt vmcnt(8)
    s_waitcnt lgkmcnt(0)
    s_barrier
    ds_read_b128 a[32:35], v10 offset:16640
    ds_read_b128 a[36:39], v10 offset:20736
    s_add_u32 m0, s81, 81920
    v_mfma_f32_32x32x16_bf16 v[160:175], v[116:119], a[16:19], v[160:175]
    ds_read_b64_tr_b16 v[96:97], v2 offset:16384
    ds_read_b64_tr_b16 v[98:99], v2 offset:16896
    s_nop 0
    buffer_load_dwordx4 v71, s[36:39], s30 offen offset:0 nt lds
    buffer_load_dwordx4 v71, s[36:39], s95 offen offset:1024 nt lds
    v_mfma_f32_32x32x16_bf16 v[176:191], v[116:119], a[20:23], v[176:191]
    ds_read_b64_tr_b16 v[100:101], v3 offset:16384
    ds_read_b64_tr_b16 v[102:103], v3 offset:16896
    s_add_u32 m0, s81, 83968
    s_nop 0
    buffer_load_dwordx4 v71, s[40:43], s30 offen offset:0 nt lds
    v_mfma_f32_32x32x16_bf16 v[128:143], v[120:123], a[24:27], v[128:143]
    ds_read_b128 a[40:43], v11 offset:16640
    ds_read_b128 a[44:47], v11 offset:20736
    buffer_load_dwordx4 v71, s[40:43], s95 offen offset:1024 nt lds
    s_add_u32 m0, s94, 157440
    v_mfma_f32_32x32x16_bf16 v[144:159], v[120:123], a[28:31], v[144:159]
    ds_read_b64_tr_b16 v[104:105], v2 offset:18432
    ds_read_b64_tr_b16 v[106:107], v2 offset:18944
    s_nop 0
    buffer_load_dwordx4 v73, s[36:39], s96 offen offset:0 nt lds
    v_mfma_f32_32x32x16_bf16 v[160:175], v[124:127], a[24:27], v[160:175]
    ds_read_b64_tr_b16 v[108:109], v3 offset:18432
    ds_read_b64_tr_b16 v[110:111], v3 offset:18944
    buffer_load_dwordx4 v[52:55], v72, s[44:47], s93 offen
    s_add_u32 m0, s82, 0
    v_mfma_f32_32x32x16_bf16 v[176:191], v[124:127], a[28:31], v[176:191]
    ds_read_b128 a[48:51], v12 offset:16640
    ds_read_b128 a[52:55], v12 offset:20736
    s_nop 0
    buffer_load_dwordx4 v18, s[32:35], s84 offen offset:0  lds
    s_mov_b32 s36, s20
    s_waitcnt lgkmcnt(10)
    v_mfma_f32_32x32x16_bf16 v[128:143], v[96:99], a[32:35], v[128:143]
    ds_read_b64_tr_b16 v[112:113], v2 offset:20480
    ds_read_b64_tr_b16 v[114:115], v2 offset:20992
    buffer_load_dwordx4 v19, s[32:35], s84 offen offset:1024  lds
    s_add_u32 s20, s20, 8192
    s_cmp_eq_u32 s20, s22
    s_cselect_b32 s20, s21, s20
    v_mfma_f32_32x32x16_bf16 v[144:159], v[96:99], a[36:39], v[144:159]
    ds_read_b64_tr_b16 v[116:117], v3 offset:20480
    ds_read_b64_tr_b16 v[118:119], v3 offset:20992
    buffer_load_dwordx4 v20, s[32:35], s84 offen offset:2048  lds
    s_mov_b32 s37, s20
    s_add_u32 s20, s20, 8192
    s_waitcnt lgkmcnt(12)
    v_mfma_f32_32x32x16_bf16 v[160:175], v[100:103], a[32:35], v[160:175]
    ds_read_b128 a[56:59], v13 offset:16640
    ds_read_b128 a[60:63], v13 offset:20736
    buffer_load_dwordx4 v21, s[32:35], s84 offen offset:3072  lds
    s_add_u32 s84, s84, 128
    s_cmp_eq_u32 s84, 896
    s_cselect_b32 s84, 0, s84
    v_mfma_f32_32x32x16_bf16 v[176:191], v[100:103], a[36:39], v[176:191]
    ds_read_b64_tr_b16 v[120:121], v2 offset:22528
    ds_read_b64_tr_b16 v[122:123], v2 offset:23040
    s_add_u32 m0, s81, 49152
    s_nop 0
    buffer_load_dwordx4 v14, s[56:59], s83 offen offset:0  lds
    s_waitcnt lgkmcnt(12)
    v_mfma_f32_32x32x16_bf16 v[128:143], v[104:107], a[40:43], v[128:143]
    ds_read_b64_tr_b16 v[124:125], v3 offset:22528
    ds_read_b64_tr_b16 v[126:127], v3 offset:23040
    buffer_load_dwordx4 v15, s[56:59], s83 offen offset:1024  lds
    s_cmp_eq_u32 s20, s22
    s_cselect_b32 s20, s21, s20
    s_mov_b32 s38, s20
    v_mfma_f32_32x32x16_bf16 v[144:159], v[104:107], a[44:47], v[144:159]
    buffer_load_dwordx4 v16, s[56:59], s83 offen offset:2048  lds
    s_add_u32 s20, s20, 8192
    s_cmp_eq_u32 s20, s22
    s_cselect_b32 s20, s21, s20
    s_mov_b32 s39, s20
    s_waitcnt lgkmcnt(12)
    v_mfma_f32_32x32x16_bf16 v[160:175], v[108:111], a[40:43], v[160:175]
    buffer_load_dwordx4 v17, s[56:59], s83 offen offset:3072  lds
    s_add_u32 s83, s83, 229376
    s_cmp_eq_u32 s83, 1605632
    s_cselect_b32 s83, 0, s83
    s_add_u32 s20, s20, 8192
    v_mfma_f32_32x32x16_bf16 v[176:191], v[108:111], a[44:47], v[176:191]
    s_cmp_eq_u32 s20, s22
    s_cselect_b32 s20, s21, s20
    s_mov_b32 s40, s20
    s_add_u32 s20, s20, 8192
    s_waitcnt lgkmcnt(8)
    v_mfma_f32_32x32x16_bf16 v[128:143], v[112:115], a[48:51], v[128:143]
    s_cmp_eq_u32 s20, s22
    s_cselect_b32 s20, s21, s20
    s_mov_b32 s41, s20
    s_add_u32 s20, s20, 8192
    s_cmp_eq_u32 s20, s22
    s_cselect_b32 s20, s21, s20
    v_mfma_f32_32x32x16_bf16 v[144:159], v[112:115], a[52:55], v[144:159]
    s_waitcnt vmcnt(14)
    s_waitcnt lgkmcnt(0)
    s_barrier
    ds_read_b128 a[64:67], v10 offset:33280
    ds_read_b128 a[68:71], v10 offset:37376
    s_add_u32 m0, s82, 16640
    v_mfma_f32_32x32x16_bf16 v[160:175], v[116:119], a[48:51], v[160:175]
    ds_read_b64_tr_b16 v[96:97], v2 offset:32768
    ds_read_b64_tr_b16 v[98:99], v2 offset:33280
    s_nop 0
    buffer_load_dwordx4 v18, s[32:35], s84 offen offset:0  lds
    s_mov_b32 s42, s20
    v_mfma_f32_32x32x16_bf16 v[176:191], v[116:119], a[52:55], v[176:191]
    ds_read_b64_tr_b16 v[100:101], v3 offset:32768
    ds_read_b64_tr_b16 v[102:103], v3 offset:33280
    buffer_load_dwordx4 v19, s[32:35], s84 offen offset:1024  lds
    v_mfma_f32_32x32x16_bf16 v[128:143], v[120:123], a[56:59], v[128:143]
    ds_read_b128 a[72:75], v11 offset:33280
    ds_read_b128 a[76:79], v11 offset:37376
    buffer_load_dwordx4 v20, s[32:35], s84 offen offset:2048  lds
    v_mfma_f32_32x32x16_bf16 v[144:159], v[120:123], a[60:63], v[144:159]
    ds_read_b64_tr_b16 v[104:105], v2 offset:34816
    ds_read_b64_tr_b16 v[106:107], v2 offset:35328
    buffer_load_dwordx4 v21, s[32:35], s84 offen offset:3072  lds
    s_add_u32 s84, s84, 128
    v_mfma_f32_32x32x16_bf16 v[160:175], v[124:127], a[56:59], v[160:175]
    ds_read_b64_tr_b16 v[108:109], v3 offset:34816
    ds_read_b64_tr_b16 v[110:111], v3 offset:35328
    s_cmp_eq_u32 s84, 896
    s_cselect_b32 s84, 0, s84
    s_add_u32 m0, s81, 65536
    v_mfma_f32_32x32x16_bf16 v[176:191], v[124:127], a[60:63], v[176:191]
    ds_read_b128 a[80:83], v12 offset:33280
    ds_read_b128 a[84:87], v12 offset:37376
    s_nop 0
    buffer_load_dwordx4 v14, s[56:59], s83 offen offset:0  lds
    s_waitcnt lgkmcnt(10)
    v_mfma_f32_32x32x16_bf16 v[128:143], v[96:99], a[64:67], v[128:143]
    ds_read_b64_tr_b16 v[112:113], v2 offset:36864
    ds_read_b64_tr_b16 v[114:115], v2 offset:37376
    buffer_load_dwordx4 v15, s[56:59], s83 offen offset:1024  lds
    v_mfma_f32_32x32x16_bf16 v[144:159], v[96:99], a[68:71], v[144:159]
    ds_read_b64_tr_b16 v[116:117], v3 offset:36864
    ds_read_b64_tr_b16 v[118:119], v3 offset:37376
    buffer_load_dwordx4 v16, s[56:59], s83 offen offset:2048  lds
    s_waitcnt lgkmcnt(12)
    v_mfma_f32_32x32x16_bf16 v[160:175], v[100:103], a[64:67], v[160:175]
    ds_read_b128 a[88:91], v13 offset:33280
    ds_read_b128 a[92:95], v13 offset:37376
    buffer_load_dwordx4 v17, s[56:59], s83 offen offset:3072  lds
    s_add_u32 s83, s83, 229376
    s_cmp_eq_u32 s83, 1605632
    s_cselect_b32 s83, 0, s83
    v_mfma_f32_32x32x16_bf16 v[176:191], v[100:103], a[68:71], v[176:191]
    ds_read_b64_tr_b16 v[120:121], v2 offset:38912
    ds_read_b64_tr_b16 v[122:123], v2 offset:39424
    s_waitcnt vmcnt(16)
    ds_read_b32 v33, v70
    ds_read2_b32 v[34:35], v70 offset0:32 offset1:64
    s_waitcnt lgkmcnt(14)
    v_mfma_f32_32x32x16_bf16 v[128:143], v[104:107], a[72:75], v[128:143]
    ds_read_b64_tr_b16 v[124:125], v3 offset:38912
    ds_read_b64_tr_b16 v[126:127], v3 offset:39424
    ds_read2_b32 v[36:37], v68 offset0:0 offset1:32
    ds_read2_b32 v[38:39], v68 offset0:64 offset1:96
    ds_read2_b32 v[40:41], v68 offset0:128 offset1:160
    ds_read2_b32 v[42:43], v68 offset0:192 offset1:224
    v_mfma_f32_32x32x16_bf16 v[144:159], v[104:107], a[76:79], v[144:159]
    ds_read2_b32 v[44:45], v69 offset0:0 offset1:32
    ds_read2_b32 v[46:47], v69 offset0:64 offset1:96
    ds_read2_b32 v[48:49], v69 offset0:128 offset1:160
    ds_read2_b32 v[50:51], v69 offset0:192 offset1:224
    v_readfirstlane_b32 s78, v32
    s_waitcnt lgkmcnt(15)
    v_mfma_f32_32x32x16_bf16 v[160:175], v[108:111], a[72:75], v[160:175]
    s_nop 3
    s_mul_i32 s78, s78, 1664525
    s_add_u32 s78, s78, 1013904223
    v_accvgpr_write_b32 a224, s78
    v_lshlrev_b32 v56, 16, v52
    v_mfma_f32_32x32x16_bf16 v[176:191], v[108:111], a[76:79], v[176:191]
    v_and_b32 v57, 0xffff0000, v52
    v_lshlrev_b32 v58, 16, v53
    v_and_b32 v59, 0xffff0000, v53
    s_waitcnt lgkmcnt(0)
    v_lshlrev_b32 v60, 16, v33
    v_mfma_f32_32x32x16_bf16 v[128:143], v[112:115], a[80:83], v[128:143]
    v_lshlrev_b32 v61, 16, v34
    v_lshlrev_b32 v62, 16, v35
    v_lshlrev_b32 v63, 16, v36
    v_lshlrev_b32 v64, 16, v37
    v_lshlrev_b32 v65, 16, v38
    v_lshlrev_b32 v66, 16, v39
    v_mfma_f32_32x32x16_bf16 v[144:159], v[112:115], a[84:87], v[144:159]
    s_waitcnt vmcnt(8)
    s_barrier
    ds_read_b128 a[96:99], v10 offset:0
    ds_read_b128 a[100:103], v10 offset:4096
    s_add_u32 m0, s82, 33280
    v_mfma_f32_32x32x16_bf16 v[160:175], v[116:119], a[80:83], v[160:175]
    ds_read_b64_tr_b16 v[96:97], v6 offset:0
    ds_read_b64_tr_b16 v[98:99], v6 offset:512
    s_nop 0
    buffer_load_dwordx4 v18, s[32:35], s84 offen offset:0  lds
    v_lshlrev_b32 v67, 16, v40
    v_lshlrev_b32 v68, 16, v41
    v_mfma_f32_32x32x16_bf16 v[176:191], v[116:119], a[84:87], v[176:191]
    ds_read_b64_tr_b16 v[100:101], v7 offset:0
    ds_read_b64_tr_b16 v[102:103], v7 offset:512
    buffer_load_dwordx4 v19, s[32:35], s84 offen offset:1024  lds
    v_lshlrev_b32 v69, 16, v42
    v_lshlrev_b32 v70, 16, v43
    v_mfma_f32_32x32x16_bf16 v[128:143], v[120:123], a[88:91], v[128:143]
    ds_read_b128 a[104:107], v11 offset:0
    ds_read_b128 a[108:111], v11 offset:4096
    buffer_load_dwordx4 v20, s[32:35], s84 offen offset:2048  lds
    v_mul_f32 v71, v67, v59
    v_fmac_f32 v71, v68, v58
    v_fmac_f32 v71, v69, v57
    v_mfma_f32_32x32x16_bf16 v[144:159], v[120:123], a[92:95], v[144:159]
    ds_read_b64_tr_b16 v[104:105], v6 offset:2048
    ds_read_b64_tr_b16 v[106:107], v6 offset:2560
    buffer_load_dwordx4 v21, s[32:35], s84 offen offset:3072  lds
    s_add_u32 s84, s84, 128
    v_fmac_f32 v71, v70, v56
    v_mfma_f32_32x32x16_bf16 v[160:175], v[124:127], a[88:91], v[160:175]
    ds_read_b64_tr_b16 v[108:109], v7 offset:2048
    ds_read_b64_tr_b16 v[110:111], v7 offset:2560
    s_cmp_eq_u32 s84, 896
    s_cselect_b32 s84, 0, s84
    s_add_u32 m0, s81, 81920
    v_mfma_f32_32x32x16_bf16 v[176:191], v[124:127], a[92:95], v[176:191]
    ds_read_b128 a[112:115], v12 offset:0
    ds_read_b128 a[116:119], v12 offset:4096
    s_nop 0
    buffer_load_dwordx4 v14, s[56:59], s83 offen offset:0  lds
    v_lshlrev_b32 v73, 16, v51
    s_waitcnt lgkmcnt(10)
    v_mfma_f32_32x32x16_bf16 v[128:143], v[96:99], a[96:99], v[128:143]
    ds_read_b64_tr_b16 v[112:113], v6 offset:4096
    ds_read_b64_tr_b16 v[114:115], v6 offset:4608
    buffer_load_dwordx4 v15, s[56:59], s83 offen offset:1024  lds
    v_mul_f32 v71, v71, v73
    v_mul_f32 v72, v66, v59
    v_fmac_f32 v72, v67, v58
    v_mfma_f32_32x32x16_bf16 v[144:159], v[96:99], a[100:103], v[144:159]
    ds_read_b64_tr_b16 v[116:117], v7 offset:4096
    ds_read_b64_tr_b16 v[118:119], v7 offset:4608
    buffer_load_dwordx4 v16, s[56:59], s83 offen offset:2048  lds
    v_fmac_f32 v72, v68, v57
    v_fmac_f32 v72, v69, v56
    s_waitcnt lgkmcnt(12)
    v_mfma_f32_32x32x16_bf16 v[160:175], v[100:103], a[96:99], v[160:175]
    ds_read_b128 a[120:123], v13 offset:0
    ds_read_b128 a[124:127], v13 offset:4096
    buffer_load_dwordx4 v17, s[56:59], s83 offen offset:3072  lds
    s_add_u32 s83, s83, 229376
    s_cmp_eq_u32 s83, 1605632
    s_cselect_b32 s83, 0, s83
    v_mfma_f32_32x32x16_bf16 v[176:191], v[100:103], a[100:103], v[176:191]
    ds_read_b64_tr_b16 v[120:121], v6 offset:6144
    ds_read_b64_tr_b16 v[122:123], v6 offset:6656
    v_lshlrev_b32 v73, 16, v50
    v_mul_f32 v72, v72, v73
    v_cvt_pk_bf16_f32 v76, v71, v72
    s_waitcnt lgkmcnt(12)
    v_mfma_f32_32x32x16_bf16 v[128:143], v[104:107], a[104:107], v[128:143]
    ds_read_b64_tr_b16 v[124:125], v7 offset:6144
    ds_read_b64_tr_b16 v[126:127], v7 offset:6656
    v_mul_f32 v71, v65, v59
    v_fmac_f32 v71, v66, v58
    v_fmac_f32 v71, v67, v57
    v_fmac_f32 v71, v68, v56
    v_mfma_f32_32x32x16_bf16 v[144:159], v[104:107], a[108:111], v[144:159]
    v_lshlrev_b32 v73, 16, v49
    v_mul_f32 v71, v71, v73
    v_mul_f32 v72, v64, v59
    v_fmac_f32 v72, v65, v58
    v_fmac_f32 v72, v66, v57
    s_waitcnt lgkmcnt(12)
    v_mfma_f32_32x32x16_bf16 v[160:175], v[108:111], a[104:107], v[160:175]
    v_fmac_f32 v72, v67, v56
    v_lshlrev_b32 v73, 16, v48
    v_mul_f32 v72, v72, v73
    v_cvt_pk_bf16_f32 v77, v71, v72
    v_mul_f32 v71, v63, v59
    v_fmac_f32 v71, v64, v58
    v_mfma_f32_32x32x16_bf16 v[176:191], v[108:111], a[108:111], v[176:191]
    v_fmac_f32 v71, v65, v57
    v_fmac_f32 v71, v66, v56
    v_lshlrev_b32 v73, 16, v47
    v_mul_f32 v71, v71, v73
    v_mul_f32 v72, v62, v59
    s_waitcnt lgkmcnt(8)
    v_mfma_f32_32x32x16_bf16 v[128:143], v[112:115], a[112:115], v[128:143]
    v_fmac_f32 v72, v63, v58
    v_fmac_f32 v72, v64, v57
    v_fmac_f32 v72, v65, v56
    v_lshlrev_b32 v73, 16, v46
    v_mul_f32 v72, v72, v73
    v_cvt_pk_bf16_f32 v78, v71, v72
    v_mfma_f32_32x32x16_bf16 v[144:159], v[112:115], a[116:119], v[144:159]
    s_waitcnt vmcnt(8)
    s_waitcnt lgkmcnt(0)
    s_barrier
    ds_read_b128 a[128:131], v10 offset:16640
    ds_read_b128 a[132:135], v10 offset:20736
    s_add_u32 m0, s82, 0
    v_mfma_f32_32x32x16_bf16 v[160:175], v[116:119], a[112:115], v[160:175]
    ds_read_b64_tr_b16 v[96:97], v6 offset:16384
    ds_read_b64_tr_b16 v[98:99], v6 offset:16896
    s_nop 0
    buffer_load_dwordx4 v18, s[32:35], s84 offen offset:0  lds
    v_mul_f32 v71, v61, v59
    v_fmac_f32 v71, v62, v58
    v_mfma_f32_32x32x16_bf16 v[176:191], v[116:119], a[116:119], v[176:191]
    ds_read_b64_tr_b16 v[100:101], v7 offset:16384
    ds_read_b64_tr_b16 v[102:103], v7 offset:16896
    buffer_load_dwordx4 v19, s[32:35], s84 offen offset:1024  lds
    v_fmac_f32 v71, v63, v57
    v_fmac_f32 v71, v64, v56
    v_mfma_f32_32x32x16_bf16 v[128:143], v[120:123], a[120:123], v[128:143]
    ds_read_b128 a[136:139], v11 offset:16640
    ds_read_b128 a[140:143], v11 offset:20736
    buffer_load_dwordx4 v20, s[32:35], s84 offen offset:2048  lds
    v_lshlrev_b32 v73, 16, v45
    v_mul_f32 v71, v71, v73
    v_mul_f32 v72, v60, v59
    v_mfma_f32_32x32x16_bf16 v[144:159], v[120:123], a[124:127], v[144:159]
    ds_read_b64_tr_b16 v[104:105], v6 offset:18432
    ds_read_b64_tr_b16 v[106:107], v6 offset:18944
    buffer_load_dwordx4 v21, s[32:35], s84 offen offset:3072  lds
    s_add_u32 s84, s84, 128
    v_fmac_f32 v72, v61, v58
    v_mfma_f32_32x32x16_bf16 v[160:175], v[124:127], a[120:123], v[160:175]
    ds_read_b64_tr_b16 v[108:109], v7 offset:18432
    ds_read_b64_tr_b16 v[110:111], v7 offset:18944
    s_cmp_eq_u32 s84, 896
    s_cselect_b32 s84, 0, s84
    s_add_u32 m0, s81, 0
    v_fmac_f32 v72, v62, v57
    v_mfma_f32_32x32x16_bf16 v[176:191], v[124:127], a[124:127], v[176:191]
    ds_read_b128 a[144:147], v12 offset:16640
    ds_read_b128 a[148:151], v12 offset:20736
    s_nop 0
    buffer_load_dwordx4 v14, s[56:59], s83 offen offset:0  lds
    v_fmac_f32 v72, v63, v56
    s_waitcnt lgkmcnt(10)
    v_mfma_f32_32x32x16_bf16 v[128:143], v[96:99], a[128:131], v[128:143]
    ds_read_b64_tr_b16 v[112:113], v6 offset:20480
    ds_read_b64_tr_b16 v[114:115], v6 offset:20992
    buffer_load_dwordx4 v15, s[56:59], s83 offen offset:1024  lds
    buffer_load_dwordx4 v16, s[56:59], s83 offen offset:2048  lds
    buffer_load_dwordx4 v17, s[56:59], s83 offen offset:3072  lds
    s_add_u32 s83, s83, 229376
    s_cmp_eq_u32 s83, 1605632
    s_cselect_b32 s83, 0, s83
    s_add_u32 m0, s81, 16384
    s_nop 0
    buffer_load_dwordx4 v14, s[56:59], s87 offen offset:0  lds
    v_mfma_f32_32x32x16_bf16 v[144:159], v[96:99], a[132:135], v[144:159]
    ds_read_b64_tr_b16 v[116:117], v7 offset:20480
    ds_read_b64_tr_b16 v[118:119], v7 offset:20992
    v_lshlrev_b32 v73, 16, v44
    v_mul_f32 v72, v72, v73
    v_cvt_pk_bf16_f32 v79, v71, v72
    s_waitcnt lgkmcnt(12)
    v_mfma_f32_32x32x16_bf16 v[160:175], v[100:103], a[128:131], v[160:175]
    ds_read_b128 a[152:155], v13 offset:16640
    ds_read_b128 a[156:159], v13 offset:20736
    buffer_load_dwordx4 v15, s[56:59], s87 offen offset:1024  lds
    v_lshlrev_b32 v56, 16, v54
    v_and_b32 v57, 0xffff0000, v54
    v_lshlrev_b32 v58, 16, v55
    v_mfma_f32_32x32x16_bf16 v[176:191], v[100:103], a[132:135], v[176:191]
    ds_read_b64_tr_b16 v[120:121], v6 offset:22528
    ds_read_b64_tr_b16 v[122:123], v6 offset:23040
    v_and_b32 v59, 0xffff0000, v55
    v_and_b32 v60, 0xffff0000, v33
    v_and_b32 v61, 0xffff0000, v34
    s_waitcnt lgkmcnt(12)
    v_mfma_f32_32x32x16_bf16 v[128:143], v[104:107], a[136:139], v[128:143]
    ds_read_b64_tr_b16 v[124:125], v7 offset:22528
    ds_read_b64_tr_b16 v[126:127], v7 offset:23040
    buffer_load_dwordx4 v16, s[56:59], s87 offen offset:2048  lds
    v_and_b32 v62, 0xffff0000, v35
    v_and_b32 v63, 0xffff0000, v36
    v_and_b32 v64, 0xffff0000, v37
    v_mfma_f32_32x32x16_bf16 v[144:159], v[104:107], a[140:143], v[144:159]
    v_and_b32 v65, 0xffff0000, v38
    v_and_b32 v66, 0xffff0000, v39
    v_and_b32 v67, 0xffff0000, v40
    v_and_b32 v68, 0xffff0000, v41
    v_and_b32 v69, 0xffff0000, v42
    s_waitcnt lgkmcnt(12)
    v_mfma_f32_32x32x16_bf16 v[160:175], v[108:111], a[136:139], v[160:175]
    buffer_load_dwordx4 v17, s[56:59], s87 offen offset:3072  lds
    s_add_u32 s87, s87, 229376
    s_cmp_eq_u32 s87, 1605760
    s_cselect_b32 s87, 128, s87
    s_add_u32 m0, s81, 32768
    v_and_b32 v70, 0xffff0000, v43
    v_mfma_f32_32x32x16_bf16 v[176:191], v[108:111], a[140:143], v[176:191]
    v_mul_f32 v71, v67, v59
    v_fmac_f32 v71, v68, v58
    v_fmac_f32 v71, v69, v57
    v_fmac_f32 v71, v70, v56
    v_and_b32 v73, 0xffff0000, v51
    s_waitcnt lgkmcnt(8)
    v_mfma_f32_32x32x16_bf16 v[128:143], v[112:115], a[144:147], v[128:143]
    s_nop 0
    buffer_load_dwordx4 v14, s[56:59], s87 offen offset:0  lds
    v_mul_f32 v71, v71, v73
    v_mul_f32 v72, v66, v59
    v_fmac_f32 v72, v67, v58
    v_fmac_f32 v72, v68, v57
    v_mfma_f32_32x32x16_bf16 v[144:159], v[112:115], a[148:151], v[144:159]
    s_waitcnt vmcnt(13)
    s_waitcnt lgkmcnt(0)
    s_barrier
    ds_read_b128 a[160:163], v10 offset:33280
    ds_read_b128 a[164:167], v10 offset:37376
    v_fmac_f32 v72, v69, v56
    v_mfma_f32_32x32x16_bf16 v[160:175], v[116:119], a[144:147], v[160:175]
    ds_read_b64_tr_b16 v[96:97], v6 offset:32768
    ds_read_b64_tr_b16 v[98:99], v6 offset:33280
    buffer_load_dwordx4 v15, s[56:59], s87 offen offset:1024  lds
    v_and_b32 v73, 0xffff0000, v50
    v_mul_f32 v72, v72, v73
    v_cvt_pk_bf16_f32 v32, v71, v72
    v_mfma_f32_32x32x16_bf16 v[176:191], v[116:119], a[148:151], v[176:191]
    ds_read_b64_tr_b16 v[100:101], v7 offset:32768
    ds_read_b64_tr_b16 v[102:103], v7 offset:33280
    v_mul_f32 v71, v65, v59
    v_fmac_f32 v71, v66, v58
    v_fmac_f32 v71, v67, v57
    v_mfma_f32_32x32x16_bf16 v[128:143], v[120:123], a[152:155], v[128:143]
    ds_read_b128 a[168:171], v11 offset:33280
    ds_read_b128 a[172:175], v11 offset:37376
    buffer_load_dwordx4 v16, s[56:59], s87 offen offset:2048  lds
    v_fmac_f32 v71, v68, v56
    v_and_b32 v73, 0xffff0000, v49
    v_mul_f32 v71, v71, v73
    v_mfma_f32_32x32x16_bf16 v[144:159], v[120:123], a[156:159], v[144:159]
    ds_read_b64_tr_b16 v[104:105], v6 offset:34816
    ds_read_b64_tr_b16 v[106:107], v6 offset:35328
    v_mul_f32 v72, v64, v59
    v_fmac_f32 v72, v65, v58
    v_fmac_f32 v72, v66, v57
    v_mfma_f32_32x32x16_bf16 v[160:175], v[124:127], a[152:155], v[160:175]
    ds_read_b64_tr_b16 v[108:109], v7 offset:34816
    ds_read_b64_tr_b16 v[110:111], v7 offset:35328
    buffer_load_dwordx4 v17, s[56:59], s87 offen offset:3072  lds
    s_add_u32 s87, s87, 229376
    s_cmp_eq_u32 s87, 1605760
    s_cselect_b32 s87, 128, s87
    v_mfma_f32_32x32x16_bf16 v[176:191], v[124:127], a[156:159], v[176:191]
    ds_read_b128 a[176:179], v12 offset:33280
    ds_read_b128 a[180:183], v12 offset:37376
    v_fmac_f32 v72, v67, v56
    v_and_b32 v73, 0xffff0000, v48
    v_mul_f32 v72, v72, v73
    s_waitcnt lgkmcnt(10)
    v_mfma_f32_32x32x16_bf16 v[128:143], v[96:99], a[160:163], v[128:143]
    ds_read_b64_tr_b16 v[112:113], v6 offset:36864
    ds_read_b64_tr_b16 v[114:115], v6 offset:37376
    v_cvt_pk_bf16_f32 v33, v71, v72
    v_mul_f32 v71, v63, v59
    v_fmac_f32 v71, v64, v58
    v_fmac_f32 v71, v65, v57
    v_mfma_f32_32x32x16_bf16 v[144:159], v[96:99], a[164:167], v[144:159]
    ds_read_b64_tr_b16 v[116:117], v7 offset:36864
    ds_read_b64_tr_b16 v[118:119], v7 offset:37376
    v_fmac_f32 v71, v66, v56
    v_and_b32 v73, 0xffff0000, v47
    v_mul_f32 v71, v71, v73
    s_waitcnt lgkmcnt(12)
    v_mfma_f32_32x32x16_bf16 v[160:175], v[100:103], a[160:163], v[160:175]
    ds_read_b128 a[184:187], v13 offset:33280
    ds_read_b128 a[188:191], v13 offset:37376
    v_mul_f32 v72, v62, v59
    v_fmac_f32 v72, v63, v58
    v_fmac_f32 v72, v64, v57
    v_fmac_f32 v72, v65, v56
    v_mfma_f32_32x32x16_bf16 v[176:191], v[100:103], a[164:167], v[176:191]
    ds_read_b64_tr_b16 v[120:121], v6 offset:38912
    ds_read_b64_tr_b16 v[122:123], v6 offset:39424
    v_and_b32 v73, 0xffff0000, v46
    v_mul_f32 v72, v72, v73
    v_cvt_pk_bf16_f32 v34, v71, v72
    s_waitcnt lgkmcnt(12)
    v_mfma_f32_32x32x16_bf16 v[128:143], v[104:107], a[168:171], v[128:143]
    ds_read_b64_tr_b16 v[124:125], v7 offset:38912
    ds_read_b64_tr_b16 v[126:127], v7 offset:39424
    v_mul_f32 v71, v61, v59
    v_fmac_f32 v71, v62, v58
    v_fmac_f32 v71, v63, v57
    v_fmac_f32 v71, v64, v56
    v_mfma_f32_32x32x16_bf16 v[144:159], v[104:107], a[172:175], v[144:159]
    v_and_b32 v73, 0xffff0000, v45
    v_mul_f32 v71, v71, v73
    v_mul_f32 v72, v60, v59
    v_fmac_f32 v72, v61, v58
    v_fmac_f32 v72, v62, v57
    s_waitcnt lgkmcnt(12)
    v_mfma_f32_32x32x16_bf16 v[160:175], v[108:111], a[168:171], v[160:175]
    v_fmac_f32 v72, v63, v56
    v_and_b32 v73, 0xffff0000, v44
    v_mul_f32 v72, v72, v73
    v_cvt_pk_bf16_f32 v35, v71, v72
    v_accvgpr_read_b32 v71, a226
    v_mfma_f32_32x32x16_bf16 v[176:191], v[108:111], a[172:175], v[176:191]
    ds_write_b128 v71, v[76:79]
    s_waitcnt lgkmcnt(9)
    v_mfma_f32_32x32x16_bf16 v[128:143], v[112:115], a[176:179], v[128:143]
    s_add_u32 m0, s81, 49152
    s_nop 0
    buffer_load_dwordx4 v14, s[56:59], s87 offen offset:0  lds
    ds_write_b128 v71, v[32:35] offset:128
    v_mfma_f32_32x32x16_bf16 v[144:159], v[112:115], a[180:183], v[144:159]
    s_waitcnt vmcnt(9)
    s_waitcnt lgkmcnt(0)
    s_barrier
    ds_read_b128 a[192:195], v10 offset:0
    ds_read_b128 a[196:199], v10 offset:4096
    v_accvgpr_read_b32 v72, a227
    v_mfma_f32_32x32x16_bf16 v[160:175], v[116:119], a[176:179], v[160:175]
    ds_read_b64_tr_b16 v[96:97], v2 offset:0
    ds_read_b64_tr_b16 v[98:99], v2 offset:512
    buffer_load_dwordx4 v15, s[56:59], s87 offen offset:1024  lds
    s_lshl_b32 s96, s79, 6
    v_xor_b32 v19, s96, v10
    ds_read_b128 v[80:83], v19 offset:4096
    v_mfma_f32_32x32x16_bf16 v[176:191], v[116:119], a[180:183], v[176:191]
    ds_read_b64_tr_b16 v[100:101], v3 offset:0
    ds_read_b64_tr_b16 v[102:103], v3 offset:512
    v_xor_b32 v19, 32, v19
    ds_read_b128 v[84:87], v19 offset:4096
    ds_read_b128 v[36:39], v72
    ds_read_b128 v[40:43], v72 offset:4608
    v_accvgpr_read_b32 v71, a228
    v_mfma_f32_32x32x16_bf16 v[128:143], v[120:123], a[184:187], v[128:143]
    ds_read_b128 a[200:203], v11 offset:0
    ds_read_b128 a[204:207], v11 offset:4096
    buffer_load_dwordx4 v16, s[56:59], s87 offen offset:2048  lds
    v_mfma_f32_32x32x16_bf16 v[144:159], v[120:123], a[188:191], v[144:159]
    ds_read_b64_tr_b16 v[104:105], v2 offset:2048
    ds_read_b64_tr_b16 v[106:107], v2 offset:2560
    v_mfma_f32_32x32x16_bf16 v[160:175], v[124:127], a[184:187], v[160:175]
    ds_read_b64_tr_b16 v[108:109], v3 offset:2048
    ds_read_b64_tr_b16 v[110:111], v3 offset:2560
    s_waitcnt lgkmcnt(6)
    buffer_store_dwordx4 v[36:39], v71, s[68:71], s7 offen sc1
    v_mfma_f32_32x32x16_bf16 v[176:191], v[124:127], a[188:191], v[176:191]
    ds_read_b128 a[208:211], v12 offset:0
    ds_read_b128 a[212:215], v12 offset:4096
    v_mfma_f32_32x32x16_bf16 v[128:143], v[96:99], a[192:195], v[128:143]
    ds_read_b64_tr_b16 v[112:113], v2 offset:4096
    ds_read_b64_tr_b16 v[114:115], v2 offset:4608
    buffer_store_dwordx4 v[40:43], v71, s[68:71], s8 offen sc1
    v_mfma_f32_32x32x16_bf16 v[144:159], v[96:99], a[196:199], v[144:159]
    ds_read_b64_tr_b16 v[116:117], v3 offset:4096
    ds_read_b64_tr_b16 v[118:119], v3 offset:4608
    v_mfma_f32_32x32x16_bf16 v[160:175], v[100:103], a[192:195], v[160:175]
    ds_read_b128 a[216:219], v13 offset:0
    ds_read_b128 a[220:223], v13 offset:4096
    buffer_load_dwordx4 v17, s[56:59], s87 offen offset:3072  lds
    s_add_u32 s87, s87, 229376
    s_cmp_eq_u32 s87, 1605760
    s_cselect_b32 s87, 128, s87
    v_mfma_f32_32x32x16_bf16 v[176:191], v[100:103], a[196:199], v[176:191]
    ds_read_b64_tr_b16 v[120:121], v2 offset:6144
    ds_read_b64_tr_b16 v[122:123], v2 offset:6656
    s_waitcnt lgkmcnt(12)
    v_mfma_f32_32x32x16_bf16 v[128:143], v[104:107], a[200:203], v[128:143]
    ds_read_b64_tr_b16 v[124:125], v3 offset:6144
    ds_read_b64_tr_b16 v[126:127], v3 offset:6656
    v_mfma_f32_32x32x16_bf16 v[144:159], v[104:107], a[204:207], v[144:159]
    s_waitcnt lgkmcnt(12)
    v_mfma_f32_32x32x16_bf16 v[160:175], v[108:111], a[200:203], v[160:175]
    v_mfma_f32_32x32x16_bf16 v[176:191], v[108:111], a[204:207], v[176:191]
    s_waitcnt lgkmcnt(8)
    v_mfma_f32_32x32x16_bf16 v[128:143], v[112:115], a[208:211], v[128:143]
    v_and_b32 v58, 511, v30
    v_lshrrev_b32 v59, 1, v58
    buffer_load_dwordx4 v[32:35], v58, s[68:71], s12 offen offset:0 sc1
    v_mfma_f32_32x32x16_bf16 v[144:159], v[112:115], a[212:215], v[144:159]
    s_waitcnt vmcnt(11)
    s_waitcnt lgkmcnt(0)
    s_barrier
    ds_read_b64_tr_b16 v[96:97], v2 offset:16384
    ds_read_b64_tr_b16 v[98:99], v2 offset:16896
    v_mfma_f32_32x32x16_bf16 v[160:175], v[116:119], a[208:211], v[160:175]
    ds_read_b64_tr_b16 v[100:101], v3 offset:16384
    ds_read_b64_tr_b16 v[102:103], v3 offset:16896
    buffer_load_dwordx4 v[36:39], v58, s[68:71], s12 offen offset:512 sc1
    v_mfma_f32_32x32x16_bf16 v[176:191], v[116:119], a[212:215], v[176:191]
    ds_read_b64_tr_b16 v[104:105], v2 offset:18432
    ds_read_b64_tr_b16 v[106:107], v2 offset:18944
    v_mfma_f32_32x32x16_bf16 v[128:143], v[120:123], a[216:219], v[128:143]
    ds_read_b64_tr_b16 v[108:109], v3 offset:18432
    ds_read_b64_tr_b16 v[110:111], v3 offset:18944
    buffer_load_dwordx2 v[48:49], v59, s[68:71], s13 offen sc1
    s_add_u32 m0, s81, 65536
    v_mfma_f32_32x32x16_bf16 v[144:159], v[120:123], a[220:223], v[144:159]
    ds_read_b64_tr_b16 v[112:113], v2 offset:20480
    ds_read_b64_tr_b16 v[114:115], v2 offset:20992
    buffer_load_dwordx2 v[52:53], v59, s[68:71], s29 offen sc1
    v_mfma_f32_32x32x16_bf16 v[160:175], v[124:127], a[216:219], v[160:175]
    ds_read_b64_tr_b16 v[116:117], v3 offset:20480
    ds_read_b64_tr_b16 v[118:119], v3 offset:20992
    s_nop 0
    buffer_load_dwordx4 v14, s[56:59], s87 offen offset:0  lds
    v_mfma_f32_32x32x16_bf16 v[176:191], v[124:127], a[220:223], v[176:191]
    ds_read_b64_tr_b16 v[120:121], v2 offset:22528
    ds_read_b64_tr_b16 v[122:123], v2 offset:23040
    s_waitcnt lgkmcnt(12)
    v_mfma_f32_32x32x16_bf16 v[192:207], v[96:99], a[0:3], 0
    ds_read_b64_tr_b16 v[124:125], v3 offset:22528
    ds_read_b64_tr_b16 v[126:127], v3 offset:23040
    buffer_load_dwordx4 v15, s[56:59], s87 offen offset:1024  lds
    v_mfma_f32_32x32x16_bf16 v[208:223], v[96:99], a[4:7], 0
    s_waitcnt lgkmcnt(12)
    v_mfma_f32_32x32x16_bf16 v[224:239], v[100:103], a[0:3], 0
    buffer_load_dwordx4 v16, s[56:59], s87 offen offset:2048  lds
    v_mfma_f32_32x32x16_bf16 v[240:255], v[100:103], a[4:7], 0
    s_waitcnt lgkmcnt(10)
    v_mfma_f32_32x32x16_bf16 v[192:207], v[104:107], a[8:11], v[192:207]
    s_lshl_b32 s94, s79, 11
    v_lshl_add_u32 v61, v30, 1, s94
    buffer_load_dwordx4 v[70:73], v61, s[48:51], s15 offen nt
    v_mfma_f32_32x32x16_bf16 v[208:223], v[104:107], a[12:15], v[208:223]
    s_waitcnt lgkmcnt(8)
    v_mfma_f32_32x32x16_bf16 v[224:239], v[108:111], a[8:11], v[224:239]
    buffer_load_dwordx4 v[74:77], v61, s[48:51], s15 offen offset:16 nt
    v_mfma_f32_32x32x16_bf16 v[240:255], v[108:111], a[12:15], v[240:255]
    s_waitcnt lgkmcnt(6)
    v_mfma_f32_32x32x16_bf16 v[192:207], v[112:115], a[16:19], v[192:207]
    buffer_load_dwordx2 v[78:79], v61, s[48:51], s15 offen offset:32 nt
    v_and_b32 v9, 15, v1
    v_lshrrev_b32 v69, 4, v1
    v_lshl_add_u32 v9, v9, 1, v69
    v_mfma_f32_32x32x16_bf16 v[208:223], v[112:115], a[20:23], v[208:223]
    s_waitcnt vmcnt(11)
    s_waitcnt lgkmcnt(0)
    s_barrier
    ds_read_b64_tr_b16 v[96:97], v2 offset:32768
    ds_read_b64_tr_b16 v[98:99], v2 offset:33280
    buffer_store_dword a224, v31, s[68:71], s9 offen sc1
    v_mfma_f32_32x32x16_bf16 v[224:239], v[116:119], a[16:19], v[224:239]
    ds_read_b64_tr_b16 v[100:101], v3 offset:32768
    ds_read_b64_tr_b16 v[102:103], v3 offset:33280
    v_subrev_u32 v9, 15, v9
    v_lshlrev_b32 v9, 1, v9
    v_add_u32 v69, 2, v9
    buffer_load_ushort v9, v9, s[48:51], s15 offen
    v_mfma_f32_32x32x16_bf16 v[240:255], v[116:119], a[20:23], v[240:255]
    ds_read_b64_tr_b16 v[104:105], v2 offset:34816
    ds_read_b64_tr_b16 v[106:107], v2 offset:35328
    buffer_load_ushort v69, v69, s[48:51], s15 offen
    v_mfma_f32_32x32x16_bf16 v[192:207], v[120:123], a[24:27], v[192:207]
    ds_read_b64_tr_b16 v[108:109], v3 offset:34816
    ds_read_b64_tr_b16 v[110:111], v3 offset:35328
    buffer_load_dwordx4 v17, s[56:59], s87 offen offset:3072  lds
    s_add_u32 s87, s87, 229376
    v_mfma_f32_32x32x16_bf16 v[208:223], v[120:123], a[28:31], v[208:223]
    ds_read_b64_tr_b16 v[112:113], v2 offset:36864
    ds_read_b64_tr_b16 v[114:115], v2 offset:37376
    s_cmp_eq_u32 s87, 1605760
    s_cselect_b32 s87, 128, s87
    v_mfma_f32_32x32x16_bf16 v[224:239], v[124:127], a[24:27], v[224:239]
    ds_read_b64_tr_b16 v[116:117], v3 offset:36864
    ds_read_b64_tr_b16 v[118:119], v3 offset:37376
    s_add_u32 m0, s81, 81920
    s_nop 0
    buffer_load_dwordx4 v14, s[56:59], s87 offen offset:0  lds
    v_mfma_f32_32x32x16_bf16 v[240:255], v[124:127], a[28:31], v[240:255]
    ds_read_b64_tr_b16 v[120:121], v2 offset:38912
    ds_read_b64_tr_b16 v[122:123], v2 offset:39424
    v_add_u32 v61, s14, v61
    s_waitcnt lgkmcnt(12)
    v_mfma_f32_32x32x16_bf16 v[192:207], v[96:99], a[32:35], v[192:207]
    ds_read_b64_tr_b16 v[124:125], v3 offset:38912
    ds_read_b64_tr_b16 v[126:127], v3 offset:39424
    buffer_load_dwordx4 v15, s[56:59], s87 offen offset:1024  lds
    v_mfma_f32_32x32x16_bf16 v[208:223], v[96:99], a[36:39], v[208:223]
    s_waitcnt vmcnt(12)
    v_xor_b32 v4, s78, v35
    v_xor_b32 v5, s78, v39
    v_xor_b32 v8, s78, v49
    s_waitcnt lgkmcnt(12)
    v_mfma_f32_32x32x16_bf16 v[224:239], v[100:103], a[32:35], v[224:239]
    v_or3_b32 v4, v4, v5, v8
    v_xor_b32 v5, s78, v53
    v_or_b32 v4, v4, v5
    v_cmp_ne_u32 vcc, 0, v4
    s_cbranch_vccnz L_slow_C
L_res_C:
    buffer_load_dwordx4 v16, s[56:59], s87 offen offset:2048  lds
    v_mfma_f32_32x32x16_bf16 v[240:255], v[100:103], a[36:39], v[240:255]
    v_mov_b32 v35, 0
    v_mov_b32 v39, 0
    v_xor_b32 v48, 0x80000000, v48
    s_waitcnt lgkmcnt(10)
    v_mfma_f32_32x32x16_bf16 v[192:207], v[104:107], a[40:43], v[192:207]
    v_cmp_gt_u32 vcc, 32, v1
    v_mov_b32 v50, 0
    v_mov_b32 v51, 0
    v_cndmask_b32 v48, 0, v48, vcc
    v_lshrrev_b32 v49, 16, v48
    buffer_load_dwordx4 v17, s[56:59], s87 offen offset:3072  lds
    v_mfma_f32_32x32x16_bf16 v[208:223], v[104:107], a[44:47], v[208:223]
    v_or_b32 v48, v48, v49
    v_xor_b32 v52, 0x80000000, v52
    s_add_u32 s87, s87, 229376
    s_waitcnt lgkmcnt(8)
    v_mfma_f32_32x32x16_bf16 v[224:239], v[108:111], a[40:43], v[224:239]
    v_cmp_gt_u32 vcc, 32, v1
    v_mov_b32 v54, 0
    v_mov_b32 v55, 0
    v_cndmask_b32 v52, 0, v52, vcc
    v_lshrrev_b32 v53, 16, v52
    s_cmp_eq_u32 s87, 1605760
    s_cselect_b32 s87, 128, s87
    s_add_u32 m0, s81, 0
    s_nop 0
    buffer_load_dwordx4 v14, s[56:59], s87 offen offset:0  lds
    v_mfma_f32_32x32x16_bf16 v[240:255], v[108:111], a[44:47], v[240:255]
    v_or_b32 v52, v52, v53
    s_waitcnt vmcnt(6)
    v_lshl_or_b32 v9, v69, 16, v9
    v_mov_b32 v88, v71
    s_waitcnt lgkmcnt(6)
    v_mfma_f32_32x32x16_bf16 v[192:207], v[112:115], a[48:51], v[192:207]
    buffer_load_dwordx4 v15, s[56:59], s87 offen offset:1024  lds
    v_mov_b32 v89, v72
    v_mov_b32 v90, v73
    v_mov_b32 v91, v74
    v_mfma_f32_32x32x16_bf16 v[208:223], v[112:115], a[52:55], v[208:223]
    s_waitcnt lgkmcnt(0)
    s_barrier
    ds_read_b64_tr_b16 v[96:97], v6 offset:0
    ds_read_b64_tr_b16 v[98:99], v6 offset:512
    v_mfma_f32_32x32x16_bf16 v[224:239], v[116:119], a[48:51], v[224:239]
    ds_read_b64_tr_b16 v[100:101], v7 offset:0
    ds_read_b64_tr_b16 v[102:103], v7 offset:512
    buffer_load_dwordx4 v16, s[56:59], s87 offen offset:2048  lds
    v_mfma_f32_32x32x16_bf16 v[240:255], v[116:119], a[52:55], v[240:255]
    ds_read_b64_tr_b16 v[104:105], v6 offset:2048
    ds_read_b64_tr_b16 v[106:107], v6 offset:2560
    v_mfma_f32_32x32x16_bf16 v[192:207], v[120:123], a[56:59], v[192:207]
    ds_read_b64_tr_b16 v[108:109], v7 offset:2048
    ds_read_b64_tr_b16 v[110:111], v7 offset:2560
    buffer_load_dwordx4 v17, s[56:59], s87 offen offset:3072  lds
    s_add_u32 s87, s87, 229376
    v_mfma_f32_32x32x16_bf16 v[208:223], v[120:123], a[60:63], v[208:223]
    ds_read_b64_tr_b16 v[112:113], v6 offset:4096
    ds_read_b64_tr_b16 v[114:115], v6 offset:4608
    s_cmp_eq_u32 s87, 1605760
    s_cselect_b32 s87, 128, s87
    v_mfma_f32_32x32x16_bf16 v[224:239], v[124:127], a[56:59], v[224:239]
    ds_read_b64_tr_b16 v[116:117], v7 offset:4096
    ds_read_b64_tr_b16 v[118:119], v7 offset:4608
    s_add_u32 m0, s81, 16384
    s_nop 0
    buffer_load_dwordx4 v14, s[56:59], s87 offen offset:0  lds
    v_mfma_f32_32x32x16_bf16 v[240:255], v[124:127], a[60:63], v[240:255]
    ds_read_b64_tr_b16 v[120:121], v6 offset:6144
    ds_read_b64_tr_b16 v[122:123], v6 offset:6656
    v_mfma_f32_32x32x16_bf16 v[128:143], v[32:35], v[48:51], v[128:143]
    ds_read_b64_tr_b16 v[124:125], v7 offset:6144
    ds_read_b64_tr_b16 v[126:127], v7 offset:6656
    buffer_load_dwordx4 v15, s[56:59], s87 offen offset:1024  lds
    v_mfma_f32_32x32x16_bf16 v[144:159], v[32:35], v[52:55], v[144:159]
    ds_write_b128 v61, v[88:91] offset:4192
    v_mov_b32 v92, v75
    v_mov_b32 v93, v76
    v_mfma_f32_32x32x16_bf16 v[160:175], v[36:39], v[48:51], v[160:175]
    buffer_load_dwordx4 v16, s[56:59], s87 offen offset:2048  lds
    s_nop 2
    v_mul_f32 v128, v128, v136
    v_mul_f32 v129, v129, v137
    v_mul_f32 v130, v130, v138
    v_mfma_f32_32x32x16_bf16 v[176:191], v[36:39], v[52:55], v[176:191]
    v_mul_f32 v131, v131, v139
    v_mul_f32 v132, v132, v140
    v_mul_f32 v133, v133, v141
    v_mul_f32 v134, v134, v142
    v_mul_f32 v135, v135, v143
    s_waitcnt lgkmcnt(15)
    v_mfma_f32_32x32x16_bf16 v[192:207], v[96:99], a[64:67], v[192:207]
    buffer_load_dwordx4 v17, s[56:59], s87 offen offset:3072  lds
    s_add_u32 s87, s87, 229376
    s_cmp_eq_u32 s87, 1605760
    s_cselect_b32 s87, 128, s87
    v_mfma_f32_32x32x16_bf16 v[208:223], v[96:99], a[68:71], v[208:223]
    v_cvt_pk_bf16_f32 v136, v128, v129
    v_cvt_pk_bf16_f32 v137, v130, v131
    v_cvt_pk_bf16_f32 v138, v132, v133
    v_cvt_pk_bf16_f32 v139, v134, v135
    s_waitcnt lgkmcnt(13)
    v_mfma_f32_32x32x16_bf16 v[224:239], v[100:103], a[64:67], v[224:239]
    s_add_u32 m0, s81, 98560
    buffer_store_dwordx4 v[136:139], v30, s[68:71], s4 offen offset:0 sc1
    v_mov_b32 v94, v77
    v_mov_b32 v95, v78
    v_mfma_f32_32x32x16_bf16 v[240:255], v[100:103], a[68:71], v[240:255]
    ds_write_b128 v61, v[92:95] offset:4208
    v_alignbyte_b32 v62, v71, v70, 2
    s_waitcnt lgkmcnt(12)
    v_mfma_f32_32x32x16_bf16 v[192:207], v[104:107], a[72:75], v[192:207]
    s_nop 0
    buffer_load_dwordx4 v22, s[60:63], s85 offen offset:0  lds
    v_alignbyte_b32 v63, v72, v71, 2
    v_alignbyte_b32 v64, v73, v72, 2
    v_mfma_f32_32x32x16_bf16 v[208:223], v[104:107], a[76:79], v[208:223]
    v_alignbyte_b32 v65, v74, v73, 2
    ds_write_b128 v61, v[72:75] offset:12512
    s_waitcnt lgkmcnt(11)
    v_mfma_f32_32x32x16_bf16 v[224:239], v[108:111], a[72:75], v[224:239]
    buffer_load_dwordx4 v23, s[60:63], s85 offen offset:1024  lds
    v_alignbyte_b32 v66, v75, v74, 2
    v_alignbyte_b32 v67, v76, v75, 2
    v_alignbyte_b32 v68, v77, v76, 2
    v_mfma_f32_32x32x16_bf16 v[240:255], v[108:111], a[76:79], v[240:255]
    v_alignbyte_b32 v69, v78, v77, 2
    ds_write_b128 v61, v[76:79] offset:12528
    s_waitcnt lgkmcnt(10)
    v_mfma_f32_32x32x16_bf16 v[192:207], v[112:115], a[80:83], v[192:207]
    buffer_load_dwordx4 v24, s[60:63], s85 offen offset:2048  lds
    v_mfma_f32_32x32x16_bf16 v[208:223], v[112:115], a[84:87], v[208:223]
    s_waitcnt vmcnt(16)
    s_waitcnt lgkmcnt(4)
    s_barrier
    ds_read_b64_tr_b16 v[96:97], v6 offset:16384
    ds_read_b64_tr_b16 v[98:99], v6 offset:16896
    v_mfma_f32_32x32x16_bf16 v[224:239], v[116:119], a[80:83], v[224:239]
    ds_read_b64_tr_b16 v[100:101], v7 offset:16384
    ds_read_b64_tr_b16 v[102:103], v7 offset:16896
    buffer_load_dwordx4 v25, s[60:63], s85 offen offset:3072  lds
    s_add_u32 s85, s85, 114688
    v_mfma_f32_32x32x16_bf16 v[240:255], v[116:119], a[84:87], v[240:255]
    ds_read_b64_tr_b16 v[104:105], v6 offset:18432
    ds_read_b64_tr_b16 v[106:107], v6 offset:18944
    s_cmp_eq_u32 s85, 802816
    s_cselect_b32 s85, 0, s85
    v_mfma_f32_32x32x16_bf16 v[192:207], v[120:123], a[88:91], v[192:207]
    ds_read_b64_tr_b16 v[108:109], v7 offset:18432
    ds_read_b64_tr_b16 v[110:111], v7 offset:18944
    v_mul_f32 v144, v144, v152
    v_mul_f32 v145, v145, v153
    v_mul_f32 v146, v146, v154
    v_mfma_f32_32x32x16_bf16 v[208:223], v[120:123], a[92:95], v[208:223]
    ds_read_b64_tr_b16 v[112:113], v6 offset:20480
    ds_read_b64_tr_b16 v[114:115], v6 offset:20992
    v_mul_f32 v147, v147, v155
    v_mul_f32 v148, v148, v156
    v_mul_f32 v149, v149, v157
    v_mul_f32 v150, v150, v158
    v_mul_f32 v151, v151, v159
    v_cvt_pk_bf16_f32 v152, v144, v145
    v_cvt_pk_bf16_f32 v153, v146, v147
    v_cvt_pk_bf16_f32 v154, v148, v149
    v_cvt_pk_bf16_f32 v155, v150, v151
    buffer_store_dwordx4 v[152:155], v30, s[68:71], s5 offen offset:0 sc1
    v_mfma_f32_32x32x16_bf16 v[224:239], v[124:127], a[88:91], v[224:239]
    ds_read_b64_tr_b16 v[116:117], v7 offset:20480
    ds_read_b64_tr_b16 v[118:119], v7 offset:20992
    ds_write_b128 v61, v[62:65] offset:32
    v_mfma_f32_32x32x16_bf16 v[240:255], v[124:127], a[92:95], v[240:255]
    ds_read_b64_tr_b16 v[120:121], v6 offset:22528
    ds_read_b64_tr_b16 v[122:123], v6 offset:23040
    s_waitcnt lgkmcnt(15)
    v_alignbyte_b32 v88, v72, v71, 2
    s_waitcnt lgkmcnt(13)
    v_mfma_f32_32x32x16_bf16 v[192:207], v[96:99], a[96:99], v[192:207]
    ds_read_b64_tr_b16 v[124:125], v7 offset:22528
    ds_read_b64_tr_b16 v[126:127], v7 offset:23040
    v_alignbyte_b32 v89, v73, v72, 2
    v_alignbyte_b32 v90, v74, v73, 2
    v_alignbyte_b32 v91, v75, v74, 2
    v_mfma_f32_32x32x16_bf16 v[208:223], v[96:99], a[100:103], v[208:223]
    ds_write_b128 v61, v[66:69] offset:48
    v_alignbyte_b32 v92, v76, v75, 2
    s_waitcnt lgkmcnt(14)
    v_mfma_f32_32x32x16_bf16 v[224:239], v[100:103], a[96:99], v[224:239]
    v_alignbyte_b32 v93, v77, v76, 2
    v_alignbyte_b32 v94, v78, v77, 2
    v_alignbyte_b32 v95, v79, v78, 2
    v_mfma_f32_32x32x16_bf16 v[240:255], v[100:103], a[100:103], v[240:255]
    ds_write_b128 v61, v[88:91] offset:8352
    s_waitcnt lgkmcnt(13)
    v_mfma_f32_32x32x16_bf16 v[192:207], v[104:107], a[104:107], v[192:207]
    v_mfma_f32_32x32x16_bf16 v[208:223], v[104:107], a[108:111], v[208:223]
    v_accvgpr_read_b32 v57, a229
    buffer_load_dword v56, v57, s[68:71], s27 offen sc1
    s_waitcnt lgkmcnt(11)
    v_mfma_f32_32x32x16_bf16 v[224:239], v[108:111], a[104:107], v[224:239]
    s_add_u32 m0, s81, 32768
    s_nop 0
    buffer_load_dwordx4 v22, s[60:63], s85 offen offset:0  lds
    v_mul_f32 v160, v160, v168
    v_mfma_f32_32x32x16_bf16 v[240:255], v[108:111], a[108:111], v[240:255]
    v_mul_f32 v161, v161, v169
    v_mul_f32 v162, v162, v170
    v_mul_f32 v163, v163, v171
    v_mul_f32 v164, v164, v172
    s_waitcnt lgkmcnt(9)
    v_mfma_f32_32x32x16_bf16 v[192:207], v[112:115], a[112:115], v[192:207]
    buffer_load_dwordx4 v[40:43], v58, s[68:71], s12 offen offset:2048 sc1
    v_mul_f32 v165, v165, v173
    v_mul_f32 v166, v166, v174
    v_mul_f32 v167, v167, v175
    v_mfma_f32_32x32x16_bf16 v[208:223], v[112:115], a[116:119], v[208:223]
    s_waitcnt vmcnt(17)
    s_waitcnt lgkmcnt(2)
    s_barrier
    ds_read_b64_tr_b16 v[96:97], v6 offset:32768
    ds_read_b64_tr_b16 v[98:99], v6 offset:33280
    v_mfma_f32_32x32x16_bf16 v[224:239], v[116:119], a[112:115], v[224:239]
    ds_read_b64_tr_b16 v[100:101], v7 offset:32768
    ds_read_b64_tr_b16 v[102:103], v7 offset:33280
    v_cvt_pk_bf16_f32 v128, v160, v161
    v_cvt_pk_bf16_f32 v129, v162, v163
    v_cvt_pk_bf16_f32 v130, v164, v165
    v_cvt_pk_bf16_f32 v131, v166, v167
    buffer_store_dwordx4 v[128:131], v30, s[68:71], s4 offen offset:1024 sc1
    v_mfma_f32_32x32x16_bf16 v[240:255], v[116:119], a[116:119], v[240:255]
    ds_read_b64_tr_b16 v[104:105], v6 offset:34816
    ds_read_b64_tr_b16 v[106:107], v6 offset:35328
    v_mfma_f32_32x32x16_bf16 v[192:207], v[120:123], a[120:123], v[192:207]
    ds_read_b64_tr_b16 v[108:109], v7 offset:34816
    ds_read_b64_tr_b16 v[110:111], v7 offset:35328
    buffer_load_dwordx4 v[44:47], v58, s[68:71], s12 offen offset:2560 sc1
    v_mfma_f32_32x32x16_bf16 v[208:223], v[120:123], a[124:127], v[208:223]
    ds_read_b64_tr_b16 v[112:113], v6 offset:36864
    ds_read_b64_tr_b16 v[114:115], v6 offset:37376
    v_mfma_f32_32x32x16_bf16 v[224:239], v[124:127], a[120:123], v[224:239]
    ds_read_b64_tr_b16 v[116:117], v7 offset:36864
    ds_read_b64_tr_b16 v[118:119], v7 offset:37376
    buffer_load_dwordx4 v23, s[60:63], s85 offen offset:1024  lds
    v_mfma_f32_32x32x16_bf16 v[240:255], v[124:127], a[124:127], v[240:255]
    ds_read_b64_tr_b16 v[120:121], v6 offset:38912
    ds_read_b64_tr_b16 v[122:123], v6 offset:39424
    s_waitcnt lgkmcnt(12)
    v_mfma_f32_32x32x16_bf16 v[192:207], v[96:99], a[128:131], v[192:207]
    ds_read_b64_tr_b16 v[124:125], v7 offset:38912
    ds_read_b64_tr_b16 v[126:127], v7 offset:39424
    buffer_load_dwordx4 v24, s[60:63], s85 offen offset:2048  lds
    v_mfma_f32_32x32x16_bf16 v[208:223], v[96:99], a[132:135], v[208:223]
    ds_write_b128 v61, v[92:95] offset:8368
    v_accvgpr_read_b32 v61, a231
    s_waitcnt lgkmcnt(13)
    v_mfma_f32_32x32x16_bf16 v[224:239], v[100:103], a[128:131], v[224:239]
    buffer_load_dwordx4 v25, s[60:63], s85 offen offset:3072  lds
    s_add_u32 s85, s85, 114688
    s_cmp_eq_u32 s85, 802816
    s_cselect_b32 s85, 0, s85
    v_mfma_f32_32x32x16_bf16 v[240:255], v[100:103], a[132:135], v[240:255]
    v_mul_f32 v176, v176, v184
    v_mul_f32 v177, v177, v185
    v_mul_f32 v178, v178, v186
    v_mul_f32 v179, v179, v187
    s_waitcnt lgkmcnt(11)
    v_mfma_f32_32x32x16_bf16 v[192:207], v[104:107], a[136:139], v[192:207]
    v_mul_f32 v180, v180, v188
    v_mul_f32 v181, v181, v189
    v_mul_f32 v182, v182, v190
    v_mul_f32 v183, v183, v191
    v_cvt_pk_bf16_f32 v132, v176, v177
    v_mfma_f32_32x32x16_bf16 v[208:223], v[104:107], a[140:143], v[208:223]
    v_cvt_pk_bf16_f32 v133, v178, v179
    v_cvt_pk_bf16_f32 v134, v180, v181
    v_cvt_pk_bf16_f32 v135, v182, v183
    buffer_store_dwordx4 v[132:135], v30, s[68:71], s5 offen offset:1024 sc1
    s_waitcnt lgkmcnt(9)
    v_mfma_f32_32x32x16_bf16 v[224:239], v[108:111], a[136:139], v[224:239]
    ds_write_b32 v61, v9
    v_mfma_f32_32x32x16_bf16 v[240:255], v[108:111], a[140:143], v[240:255]
    s_waitcnt lgkmcnt(8)
    v_mfma_f32_32x32x16_bf16 v[192:207], v[112:115], a[144:147], v[192:207]
    s_waitcnt vmcnt(8)
    v_cmp_ne_u32 vcc, s78, v56
    s_cbranch_vccnz L_slow_K
L_res_K:
    v_lshlrev_b32 v60, 4, v0
    v_mfma_f32_32x32x16_bf16 v[208:223], v[112:115], a[148:151], v[208:223]
    s_waitcnt lgkmcnt(2)
    s_barrier
    ds_read_b64_tr_b16 v[96:97], v2 offset:0
    ds_read_b64_tr_b16 v[98:99], v2 offset:512
    buffer_load_dwordx4 v[14:17], v60, s[68:71], s10 offen sc1
    v_mfma_f32_32x32x16_bf16 v[224:239], v[116:119], a[144:147], v[224:239]
    ds_read_b64_tr_b16 v[100:101], v2 offset:2048
    ds_read_b64_tr_b16 v[102:103], v2 offset:2560
    v_mfma_f32_32x32x16_bf16 v[240:255], v[116:119], a[148:151], v[240:255]
    ds_read_b64_tr_b16 v[104:105], v2 offset:4096
    ds_read_b64_tr_b16 v[106:107], v2 offset:4608
    buffer_load_dwordx4 v[18:21], v60, s[68:71], s11 offen sc1
    v_mfma_f32_32x32x16_bf16 v[192:207], v[120:123], a[152:155], v[192:207]
    ds_read_b64_tr_b16 v[108:109], v2 offset:6144
    ds_read_b64_tr_b16 v[110:111], v2 offset:6656
    v_add_u32 v60, 148224, v60
    s_add_u32 m0, s81, 49152
    v_mfma_f32_32x32x16_bf16 v[208:223], v[120:123], a[156:159], v[208:223]
    s_nop 0
    buffer_load_dwordx4 v22, s[60:63], s85 offen offset:0  lds
    v_mfma_f32_32x32x16_bf16 v[224:239], v[124:127], a[152:155], v[224:239]
    v_mfma_f32_32x32x16_bf16 v[240:255], v[124:127], a[156:159], v[240:255]
    buffer_load_dwordx4 v23, s[60:63], s85 offen offset:1024  lds
    s_waitcnt lgkmcnt(6)
    v_mfma_f32_32x32x16_bf16 v[192:207], v[96:99], a[160:163], v[192:207]
    v_mfma_f32_32x32x16_bf16 v[208:223], v[96:99], a[164:167], v[208:223]
    s_barrier
    ds_read_b64_tr_b16 v[112:113], v2 offset:16384
    ds_read_b64_tr_b16 v[114:115], v2 offset:16896
    buffer_load_dwordx4 v24, s[60:63], s85 offen offset:2048  lds
    s_waitcnt lgkmcnt(6)
    v_mfma_f32_32x32x16_bf16 v[192:207], v[100:103], a[168:171], v[192:207]
    ds_read_b64_tr_b16 v[116:117], v2 offset:18432
    ds_read_b64_tr_b16 v[118:119], v2 offset:18944
    v_mfma_f32_32x32x16_bf16 v[208:223], v[100:103], a[172:175], v[208:223]
    ds_read_b64_tr_b16 v[120:121], v2 offset:20480
    ds_read_b64_tr_b16 v[122:123], v2 offset:20992
    buffer_load_dwordx4 v25, s[60:63], s85 offen offset:3072  lds
    s_waitcnt lgkmcnt(8)
    v_mfma_f32_32x32x16_bf16 v[192:207], v[104:107], a[176:179], v[192:207]
    ds_read_b64_tr_b16 v[124:125], v2 offset:22528
    ds_read_b64_tr_b16 v[126:127], v2 offset:23040
    s_add_u32 s85, s85, 114688
    s_cmp_eq_u32 s85, 802816
    s_cselect_b32 s85, 0, s85
    v_mfma_f32_32x32x16_bf16 v[208:223], v[104:107], a[180:183], v[208:223]
    ds_read_b64_tr_b16 v[96:97], v3 offset:0
    ds_read_b64_tr_b16 v[98:99], v3 offset:512
    s_waitcnt lgkmcnt(10)
    v_mfma_f32_32x32x16_bf16 v[192:207], v[108:111], a[184:187], v[192:207]
    ds_read_b64_tr_b16 v[100:101], v3 offset:2048
    ds_read_b64_tr_b16 v[102:103], v3 offset:2560
    s_add_u32 m0, s81, 65536
    s_nop 0
    buffer_load_dwordx4 v22, s[60:63], s85 offen offset:0  lds
    v_mfma_f32_32x32x16_bf16 v[208:223], v[108:111], a[188:191], v[208:223]
    ds_read_b64_tr_b16 v[104:105], v3 offset:4096
    ds_read_b64_tr_b16 v[106:107], v3 offset:4608
    s_waitcnt lgkmcnt(12)
    v_mfma_f32_32x32x16_bf16 v[192:207], v[112:115], a[192:195], v[192:207]
    ds_read_b64_tr_b16 v[108:109], v3 offset:6144
    ds_read_b64_tr_b16 v[110:111], v3 offset:6656
    buffer_load_dwordx4 v23, s[60:63], s85 offen offset:1024  lds
    v_mfma_f32_32x32x16_bf16 v[208:223], v[112:115], a[196:199], v[208:223]
    s_waitcnt vmcnt(12)
    v_xor_b32 v4, s78, v43
    v_xor_b32 v5, s78, v47
    v_or_b32 v4, v4, v5
    s_waitcnt lgkmcnt(12)
    v_mfma_f32_32x32x16_bf16 v[192:207], v[116:119], a[200:203], v[192:207]
    ds_read_b64_tr_b16 v[112:113], v3 offset:16384
    ds_read_b64_tr_b16 v[114:115], v3 offset:16896
    v_cmp_ne_u32 vcc, 0, v4
    s_cbranch_vccnz L_slow_C2
L_res_C2:
    v_mov_b32 v43, 0
    buffer_load_dwordx4 v24, s[60:63], s85 offen offset:2048  lds
    v_mfma_f32_32x32x16_bf16 v[208:223], v[116:119], a[204:207], v[208:223]
    v_mov_b32 v47, 0
    s_waitcnt lgkmcnt(12)
    v_mfma_f32_32x32x16_bf16 v[192:207], v[120:123], a[208:211], v[192:207]
    ds_read_b64_tr_b16 v[116:117], v3 offset:18432
    ds_read_b64_tr_b16 v[118:119], v3 offset:18944
    buffer_load_dwordx4 v25, s[60:63], s85 offen offset:3072  lds
    s_add_u32 s85, s85, 114688
    v_mfma_f32_32x32x16_bf16 v[208:223], v[120:123], a[212:215], v[208:223]
    s_cmp_eq_u32 s85, 802816
    s_cselect_b32 s85, 0, s85
    s_waitcnt lgkmcnt(12)
    v_mfma_f32_32x32x16_bf16 v[192:207], v[124:127], a[216:219], v[192:207]
    ds_read_b64_tr_b16 v[120:121], v3 offset:20480
    ds_read_b64_tr_b16 v[122:123], v3 offset:20992
    v_mfma_f32_32x32x16_bf16 v[208:223], v[124:127], a[220:223], v[208:223]
    v_mfma_f32_32x32x16_bf16 v[192:207], v[40:43], v[48:51], v[192:207]
    ds_read_b64_tr_b16 v[124:125], v3 offset:22528
    ds_read_b64_tr_b16 v[126:127], v3 offset:23040
    v_mfma_f32_32x32x16_bf16 v[208:223], v[40:43], v[52:55], v[208:223]
    s_waitcnt vmcnt(10)
    buffer_store_dword a224, v31, s[68:71], s6 offen offset:0 sc1
    s_waitcnt lgkmcnt(14)
    v_mfma_f32_32x32x16_bf16 v[224:239], v[96:99], a[160:163], v[224:239]
    s_nop 4
    v_mul_f32 v192, v192, v200
    v_mul_f32 v193, v193, v201
    v_mul_f32 v194, v194, v202
    v_mul_f32 v195, v195, v203
    v_mul_f32 v196, v196, v204
    v_mfma_f32_32x32x16_bf16 v[240:255], v[96:99], a[164:167], v[240:255]
    s_waitcnt vmcnt(9)
    ds_write_b128 v60, v[14:17]
    s_waitcnt lgkmcnt(13)
    v_mfma_f32_32x32x16_bf16 v[224:239], v[100:103], a[168:171], v[224:239]
    v_mul_f32 v197, v197, v205
    v_mul_f32 v198, v198, v206
    v_mul_f32 v199, v199, v207
    v_cvt_pk_bf16_f32 v140, v192, v193
    v_cvt_pk_bf16_f32 v141, v194, v195
    v_mfma_f32_32x32x16_bf16 v[240:255], v[100:103], a[172:175], v[240:255]
    ds_write_b128 v60, v[18:21] offset:4608
    v_cvt_pk_bf16_f32 v142, v196, v197
    v_cvt_pk_bf16_f32 v143, v198, v199
    buffer_store_dwordx4 v[140:143], v30, s[68:71], s4 offen offset:2048 sc1
    s_waitcnt lgkmcnt(12)
    v_mfma_f32_32x32x16_bf16 v[224:239], v[104:107], a[176:179], v[224:239]
    v_mul_f32 v208, v208, v216
    v_mul_f32 v209, v209, v217
    v_mul_f32 v210, v210, v218
    v_mul_f32 v211, v211, v219
    v_mul_f32 v212, v212, v220
    v_mfma_f32_32x32x16_bf16 v[240:255], v[104:107], a[180:183], v[240:255]
    v_mul_f32 v213, v213, v221
    v_mul_f32 v214, v214, v222
    v_mul_f32 v215, v215, v223
    v_cvt_pk_bf16_f32 v144, v208, v209
    s_waitcnt lgkmcnt(10)
    v_mfma_f32_32x32x16_bf16 v[224:239], v[108:111], a[184:187], v[224:239]
    v_cvt_pk_bf16_f32 v145, v210, v211
    v_cvt_pk_bf16_f32 v146, v212, v213
    v_cvt_pk_bf16_f32 v147, v214, v215
    buffer_store_dwordx4 v[144:147], v30, s[68:71], s5 offen offset:2048 sc1
    v_mfma_f32_32x32x16_bf16 v[240:255], v[108:111], a[188:191], v[240:255]
    s_waitcnt lgkmcnt(8)
    v_mfma_f32_32x32x16_bf16 v[224:239], v[112:115], a[192:195], v[224:239]
    s_waitcnt lgkmcnt(0)
    s_barrier
    v_accvgpr_read_b32 v14, a230
    v_accvgpr_read_b32 v16, a232
    v_accvgpr_read_b32 v17, a233
    v_mfma_f32_32x32x16_bf16 v[240:255], v[112:115], a[196:199], v[240:255]
    s_add_u32 m0, s81, 81920
    s_nop 0
    buffer_load_dwordx4 v22, s[60:63], s85 offen offset:0  lds
    v_mfma_f32_32x32x16_bf16 v[224:239], v[116:119], a[200:203], v[224:239]
    ds_read_b64 v[160:161], v14 offset:0
    ds_read_b64 v[162:163], v14 offset:8
    ds_read_b128 v[164:167], v16 offset:3584
    v_mov_b32 v2, v80
    v_mov_b32 v3, v81
    v_mfma_f32_32x32x16_bf16 v[240:255], v[116:119], a[204:207], v[240:255]
    buffer_load_dwordx4 v23, s[60:63], s85 offen offset:1024  lds
    ds_read_b64 v[168:169], v14 offset:512
    ds_read_b64 v[170:171], v14 offset:520
    v_mfma_f32_32x32x16_bf16 v[224:239], v[120:123], a[208:211], v[224:239]
    ds_read_b128 v[172:175], v16 offset:3072
    ds_read_b64 v[176:177], v14 offset:1024
    ds_read_b64 v[178:179], v14 offset:1032
    v_mov_b32 v4, v82
    v_mov_b32 v5, v83
    v_mfma_f32_32x32x16_bf16 v[240:255], v[120:123], a[212:215], v[240:255]
    buffer_load_dwordx4 v24, s[60:63], s85 offen offset:2048  lds
    ds_read_b128 v[180:183], v16 offset:2560
    ds_read_b64 v[184:185], v14 offset:1536
    v_mfma_f32_32x32x16_bf16 v[224:239], v[124:127], a[216:219], v[224:239]
    ds_read_b64 v[186:187], v14 offset:1544
    ds_read_b128 v[188:191], v16 offset:2048
    ds_read_b64 v[96:97], v14 offset:2048
    v_mov_b32 v6, v84
    v_mov_b32 v7, v85
    v_mfma_f32_32x32x16_bf16 v[240:255], v[124:127], a[220:223], v[240:255]
    buffer_load_dwordx4 v25, s[60:63], s85 offen offset:3072  lds
    s_add_u32 s85, s85, 114688
    ds_read_b64 v[98:99], v14 offset:2056
    v_mfma_f32_32x32x16_bf16 v[224:239], v[44:47], v[48:51], v[224:239]
    s_cmp_eq_u32 s85, 802816
    s_cselect_b32 s85, 0, s85
    s_add_u32 m0, s81, 0
    ds_read_b128 v[100:103], v16 offset:1536
    ds_read_b64 v[104:105], v14 offset:2560
    v_mfma_f32_32x32x16_bf16 v[240:255], v[44:47], v[52:55], v[240:255]
    s_nop 0
    buffer_load_dwordx4 v22, s[60:63], s85 offen offset:0  lds
    ds_read_b64 v[106:107], v14 offset:2568
    ds_read_b128 v[108:111], v16 offset:1024
    s_waitcnt lgkmcnt(15)
    v_mfma_f32_16x16x32_bf16 v[32:35], v[160:163], v[164:167], 0
    ds_read_b64 v[112:113], v14 offset:3072
    s_waitcnt lgkmcnt(13)
    v_mfma_f32_16x16x32_bf16 v[36:39], v[160:163], v[172:175], 0
    v_mul_f32 v224, v224, v232
    v_mfma_f32_16x16x32_bf16 v[36:39], v[168:171], v[164:167], v[36:39]
    buffer_load_dwordx4 v23, s[60:63], s85 offen offset:1024  lds
    v_mfma_f32_16x16x32_bf16 v[40:43], v[168:171], v[172:175], 0
    v_mul_f32 v225, v225, v233
    s_waitcnt lgkmcnt(10)
    v_mfma_f32_16x16x32_bf16 v[40:43], v[160:163], v[180:183], v[40:43]
    v_mul_f32 v226, v226, v234
    v_mfma_f32_16x16x32_bf16 v[44:47], v[168:171], v[180:183], 0
    v_mul_f32 v227, v227, v235
    v_mfma_f32_16x16x32_bf16 v[40:43], v[176:179], v[164:167], v[40:43]
    buffer_load_dwordx4 v24, s[60:63], s85 offen offset:2048  lds
    v_mfma_f32_16x16x32_bf16 v[44:47], v[176:179], v[172:175], v[44:47]
    v_mul_f32 v228, v228, v236
    v_mfma_f32_16x16x32_bf16 v[48:51], v[176:179], v[180:183], 0
    v_mul_f32 v229, v229, v237
    s_waitcnt lgkmcnt(7)
    v_mfma_f32_16x16x32_bf16 v[44:47], v[160:163], v[188:191], v[44:47]
    v_mul_f32 v230, v230, v238
    v_mfma_f32_16x16x32_bf16 v[48:51], v[168:171], v[188:191], v[48:51]
    v_mul_f32 v231, v231, v239
    v_cvt_pk_bf16_f32 v148, v224, v225
    v_cvt_pk_bf16_f32 v149, v226, v227
    v_cvt_pk_bf16_f32 v150, v228, v229
    v_cvt_pk_bf16_f32 v151, v230, v231
    buffer_store_dwordx4 v[148:151], v30, s[68:71], s4 offen offset:3072 sc1
    v_mfma_f32_16x16x32_bf16 v[52:55], v[176:179], v[188:191], 0
    v_mul_f32 v240, v240, v248
    v_mfma_f32_16x16x32_bf16 v[44:47], v[184:187], v[164:167], v[44:47]
    v_mul_f32 v241, v241, v249
    v_mfma_f32_16x16x32_bf16 v[48:51], v[184:187], v[172:175], v[48:51]
    v_mul_f32 v242, v242, v250
    v_mfma_f32_16x16x32_bf16 v[52:55], v[184:187], v[180:183], v[52:55]
    v_mul_f32 v243, v243, v251
    v_mul_f32 v244, v244, v252
    v_mul_f32 v245, v245, v253
    v_mul_f32 v246, v246, v254
    v_mul_f32 v247, v247, v255
    v_cvt_pk_bf16_f32 v156, v240, v241
    v_cvt_pk_bf16_f32 v157, v242, v243
    v_cvt_pk_bf16_f32 v158, v244, v245
    v_cvt_pk_bf16_f32 v159, v246, v247
    buffer_store_dwordx4 v[156:159], v30, s[68:71], s5 offen offset:3072 sc1
    v_mfma_f32_16x16x32_bf16 v[56:59], v[184:187], v[188:191], 0
    ds_read_b64 v[114:115], v14 offset:3080
    s_waitcnt lgkmcnt(5)
    v_mfma_f32_16x16x32_bf16 v[48:51], v[160:163], v[100:103], v[48:51]
    ds_read_b128 v[116:119], v16 offset:512
    v_mfma_f32_16x16x32_bf16 v[52:55], v[168:171], v[100:103], v[52:55]
    ds_read_b64 v[120:121], v14 offset:3584
    v_mfma_f32_16x16x32_bf16 v[56:59], v[176:179], v[100:103], v[56:59]
    buffer_load_dwordx4 v25, s[60:63], s85 offen offset:3072  lds
    v_mfma_f32_16x16x32_bf16 v[60:63], v[184:187], v[100:103], 0
    s_add_u32 s85, s85, 114688
    v_mfma_f32_16x16x32_bf16 v[48:51], v[96:99], v[164:167], v[48:51]
    s_cmp_eq_u32 s85, 802816
    s_cselect_b32 s85, 0, s85
    v_mfma_f32_16x16x32_bf16 v[52:55], v[96:99], v[172:175], v[52:55]
    s_add_u32 m0, s81, 16384
    v_mfma_f32_16x16x32_bf16 v[56:59], v[96:99], v[180:183], v[56:59]
    s_nop 0
    buffer_load_dwordx4 v22, s[60:63], s85 offen offset:0  lds
    v_mfma_f32_16x16x32_bf16 v[60:63], v[96:99], v[188:191], v[60:63]
    ds_read_b64 v[122:123], v14 offset:3592
    s_waitcnt lgkmcnt(5)
    v_mfma_f32_16x16x32_bf16 v[52:55], v[160:163], v[108:111], v[52:55]
    ds_read_b128 v[124:127], v16 offset:0
    v_mfma_f32_16x16x32_bf16 v[56:59], v[168:171], v[108:111], v[56:59]
    ds_read_b64 v[192:193], v14 offset:64
    v_mfma_f32_16x16x32_bf16 v[60:63], v[176:179], v[108:111], v[60:63]
    buffer_load_dwordx4 v23, s[60:63], s85 offen offset:1024  lds
    v_mfma_f32_16x16x32_bf16 v[52:55], v[104:107], v[164:167], v[52:55]
    ds_read_b64 v[194:195], v14 offset:72
    v_mfma_f32_16x16x32_bf16 v[56:59], v[104:107], v[172:175], v[56:59]
    ds_read_b128 v[196:199], v16 offset:3648
    v_mfma_f32_16x16x32_bf16 v[60:63], v[104:107], v[180:183], v[60:63]
    ds_read_b64 v[200:201], v14 offset:576
    ds_read_b64 v[202:203], v14 offset:584
    ds_read_b128 v[204:207], v16 offset:3136
    s_waitcnt lgkmcnt(9)
    v_mfma_f32_16x16x32_bf16 v[56:59], v[160:163], v[116:119], v[56:59]
    buffer_load_dwordx4 v24, s[60:63], s85 offen offset:2048  lds
    v_mfma_f32_16x16x32_bf16 v[60:63], v[168:171], v[116:119], v[60:63]
    ds_read_b64 v[208:209], v14 offset:1088
    v_mfma_f32_16x16x32_bf16 v[56:59], v[112:115], v[164:167], v[56:59]
    ds_read_b64 v[210:211], v14 offset:1096
    ds_read_b128 v[212:215], v16 offset:2624
    v_mfma_f32_16x16x32_bf16 v[60:63], v[112:115], v[172:175], v[60:63]
    ds_read_b64 v[216:217], v14 offset:1600
    s_waitcnt lgkmcnt(10)
    v_mfma_f32_16x16x32_bf16 v[60:63], v[160:163], v[124:127], v[60:63]
    buffer_load_dwordx4 v25, s[60:63], s85 offen offset:3072  lds
    v_mfma_f32_16x16x32_bf16 v[60:63], v[120:123], v[164:167], v[60:63]
    s_add_u32 s85, s85, 114688
    s_waitcnt lgkmcnt(7)
    v_mfma_f32_16x16x32_bf16 v[32:35], v[192:195], v[196:199], v[32:35]
    s_cmp_eq_u32 s85, 802816
    s_cselect_b32 s85, 0, s85
    s_waitcnt lgkmcnt(4)
    v_mfma_f32_16x16x32_bf16 v[36:39], v[192:195], v[204:207], v[36:39]
    ds_read_b64 v[218:219], v14 offset:1608
    ds_read_b128 v[220:223], v16 offset:2112
    v_mfma_f32_16x16x32_bf16 v[36:39], v[200:203], v[196:199], v[36:39]
    ds_read_b64 v[224:225], v14 offset:2112
    v_mfma_f32_16x16x32_bf16 v[40:43], v[200:203], v[204:207], v[40:43]
    ds_read_b64 v[226:227], v14 offset:2120
    s_waitcnt lgkmcnt(5)
    v_mfma_f32_16x16x32_bf16 v[40:43], v[192:195], v[212:215], v[40:43]
    ds_read_b128 v[228:231], v16 offset:1600
    v_mfma_f32_16x16x32_bf16 v[44:47], v[200:203], v[212:215], v[44:47]
    ds_read_b64 v[232:233], v14 offset:2624
    v_mfma_f32_16x16x32_bf16 v[40:43], v[208:211], v[196:199], v[40:43]
    ds_read_b64 v[234:235], v14 offset:2632
    v_mfma_f32_16x16x32_bf16 v[44:47], v[208:211], v[204:207], v[44:47]
    ds_read_b128 v[236:239], v16 offset:1088
    v_mfma_f32_16x16x32_bf16 v[48:51], v[208:211], v[212:215], v[48:51]
    ds_read_b64 v[240:241], v14 offset:3136
    v_mov_b32 v8, v86
    v_mov_b32 v9, v87
    v_accvgpr_read_b32 v19, a234
    s_lshr_b32 s95, s15, 11
    v_mov_b32 v21, 0
    buffer_load_ushort v0, v21, s[52:55], s95 offen
    s_waitcnt lgkmcnt(7)
    v_mfma_f32_16x16x32_bf16 v[44:47], v[192:195], v[220:223], v[44:47]
    ds_read_b64 v[242:243], v14 offset:3144
    v_mfma_f32_16x16x32_bf16 v[48:51], v[200:203], v[220:223], v[48:51]
    ds_read_b128 v[244:247], v16 offset:576
    v_mfma_f32_16x16x32_bf16 v[52:55], v[208:211], v[220:223], v[52:55]
    ds_read_b64 v[248:249], v14 offset:3648
    v_mfma_f32_16x16x32_bf16 v[44:47], v[216:219], v[196:199], v[44:47]
    ds_read_b64 v[250:251], v14 offset:3656
    v_mfma_f32_16x16x32_bf16 v[48:51], v[216:219], v[204:207], v[48:51]
    ds_read_b128 v[252:255], v16 offset:64
    v_mfma_f32_16x16x32_bf16 v[52:55], v[216:219], v[212:215], v[52:55]
    ds_read_b64 v[160:161], v14 offset:128
    v_mfma_f32_16x16x32_bf16 v[56:59], v[216:219], v[220:223], v[56:59]
    ds_read_b64 v[162:163], v14 offset:136
    s_waitcnt lgkmcnt(11)
    v_mfma_f32_16x16x32_bf16 v[48:51], v[192:195], v[228:231], v[48:51]
    ds_read_b128 v[164:167], v16 offset:3712
    v_mfma_f32_16x16x32_bf16 v[52:55], v[200:203], v[228:231], v[52:55]
    ds_read_b64 v[168:169], v14 offset:640
    v_mfma_f32_16x16x32_bf16 v[56:59], v[208:211], v[228:231], v[56:59]
    ds_read_b64 v[170:171], v14 offset:648
    v_mfma_f32_16x16x32_bf16 v[60:63], v[216:219], v[228:231], v[60:63]
    ds_read_b128 v[172:175], v16 offset:3200
    v_mfma_f32_16x16x32_bf16 v[48:51], v[224:227], v[196:199], v[48:51]
    ds_read_b64 v[176:177], v14 offset:1152
    v_mfma_f32_16x16x32_bf16 v[52:55], v[224:227], v[204:207], v[52:55]
    ds_read_b64 v[178:179], v14 offset:1160
    v_mfma_f32_16x16x32_bf16 v[56:59], v[224:227], v[212:215], v[56:59]
    ds_read_b128 v[180:183], v16 offset:2688
    v_mfma_f32_16x16x32_bf16 v[60:63], v[224:227], v[220:223], v[60:63]
    ds_read_b64 v[184:185], v14 offset:1664
    s_waitcnt lgkmcnt(15)
    v_mfma_f32_16x16x32_bf16 v[52:55], v[192:195], v[236:239], v[52:55]
    ds_read_b64 v[186:187], v14 offset:1672
    v_accvgpr_read_b32 v21, a235
    v_add_u32 v10, s25, v30
    v_add_u32 v11, s26, v30
    buffer_load_dword v13, v21, s[68:71], s28 offen offset:0 sc1
    v_mfma_f32_16x16x32_bf16 v[56:59], v[200:203], v[236:239], v[56:59]
    ds_read_b128 v[188:191], v16 offset:2176
    v_mfma_f32_16x16x32_bf16 v[60:63], v[208:211], v[236:239], v[60:63]
    ds_read_b64 v[96:97], v14 offset:2176
    v_mfma_f32_16x16x32_bf16 v[52:55], v[232:235], v[196:199], v[52:55]
    ds_read_b64 v[98:99], v14 offset:2184
    v_mfma_f32_16x16x32_bf16 v[56:59], v[232:235], v[204:207], v[56:59]
    ds_read_b128 v[100:103], v16 offset:1664
    v_mfma_f32_16x16x32_bf16 v[60:63], v[232:235], v[212:215], v[60:63]
    ds_read_b64 v[104:105], v14 offset:2688
    s_waitcnt lgkmcnt(15)
    v_mfma_f32_16x16x32_bf16 v[56:59], v[192:195], v[244:247], v[56:59]
    ds_read_b64 v[106:107], v14 offset:2696
    v_mfma_f32_16x16x32_bf16 v[60:63], v[200:203], v[244:247], v[60:63]
    ds_read_b128 v[108:111], v16 offset:1152
    v_mfma_f32_16x16x32_bf16 v[56:59], v[240:243], v[196:199], v[56:59]
    ds_read_b64 v[112:113], v14 offset:3200
    v_mfma_f32_16x16x32_bf16 v[60:63], v[240:243], v[204:207], v[60:63]
    ds_read_b64 v[114:115], v14 offset:3208
    v_mfma_f32_16x16x32_bf16 v[60:63], v[192:195], v[252:255], v[60:63]
    ds_read_b128 v[116:119], v16 offset:640
    v_mfma_f32_16x16x32_bf16 v[60:63], v[248:251], v[196:199], v[60:63]
    ds_read_b64 v[120:121], v14 offset:3712
    s_waitcnt lgkmcnt(15)
    v_mfma_f32_16x16x32_bf16 v[32:35], v[160:163], v[164:167], v[32:35]
    ds_read_b64 v[122:123], v14 offset:3720
    v_mfma_f32_16x16x32_bf16 v[36:39], v[160:163], v[172:175], v[36:39]
    ds_read_b128 v[124:127], v16 offset:128
    v_mfma_f32_16x16x32_bf16 v[36:39], v[168:171], v[164:167], v[36:39]
    ds_read_b64 v[192:193], v14 offset:192
    v_mfma_f32_16x16x32_bf16 v[40:43], v[168:171], v[172:175], v[40:43]
    ds_read_b64 v[194:195], v14 offset:200
    s_waitcnt lgkmcnt(15)
    v_mfma_f32_16x16x32_bf16 v[40:43], v[160:163], v[180:183], v[40:43]
    ds_read_b128 v[196:199], v16 offset:3776
    v_mfma_f32_16x16x32_bf16 v[44:47], v[168:171], v[180:183], v[44:47]
    ds_read_b64 v[200:201], v14 offset:704
    v_mfma_f32_16x16x32_bf16 v[40:43], v[176:179], v[164:167], v[40:43]
    ds_read_b64 v[202:203], v14 offset:712
    v_mfma_f32_16x16x32_bf16 v[44:47], v[176:179], v[172:175], v[44:47]
    ds_read_b128 v[204:207], v16 offset:3264
    v_mfma_f32_16x16x32_bf16 v[48:51], v[176:179], v[180:183], v[48:51]
    ds_read_b64 v[208:209], v14 offset:1216
    s_waitcnt lgkmcnt(15)
    v_mfma_f32_16x16x32_bf16 v[44:47], v[160:163], v[188:191], v[44:47]
    ds_read_b64 v[210:211], v14 offset:1224
    v_mfma_f32_16x16x32_bf16 v[48:51], v[168:171], v[188:191], v[48:51]
    ds_read_b128 v[212:215], v16 offset:2752
    v_mfma_f32_16x16x32_bf16 v[52:55], v[176:179], v[188:191], v[52:55]
    ds_read_b64 v[216:217], v14 offset:1728
    v_mfma_f32_16x16x32_bf16 v[44:47], v[184:187], v[164:167], v[44:47]
    ds_read_b64 v[218:219], v14 offset:1736
    v_mfma_f32_16x16x32_bf16 v[48:51], v[184:187], v[172:175], v[48:51]
    ds_read_b128 v[220:223], v16 offset:2240
    v_mfma_f32_16x16x32_bf16 v[52:55], v[184:187], v[180:183], v[52:55]
    ds_read_b64 v[224:225], v14 offset:2240
    v_mfma_f32_16x16x32_bf16 v[56:59], v[184:187], v[188:191], v[56:59]
    ds_read_b64 v[226:227], v14 offset:2248
    v_mfma_f32_16x16x32_bf16 v[48:51], v[160:163], v[100:103], v[48:51]
    ds_read_b128 v[228:231], v16 offset:1728
    v_mfma_f32_16x16x32_bf16 v[52:55], v[168:171], v[100:103], v[52:55]
    ds_read_b64 v[232:233], v14 offset:2752
    v_mfma_f32_16x16x32_bf16 v[56:59], v[176:179], v[100:103], v[56:59]
    ds_read_b64 v[234:235], v14 offset:2760
    s_waitcnt vmcnt(0)
    v_cmp_ne_u32 vcc, s78, v13
    s_cbranch_vccnz L_slow_H
L_res_H:
    buffer_load_dwordx4 v[64:67], v10, s[68:71], s37 offen offset:0 sc1
    v_mfma_f32_16x16x32_bf16 v[60:63], v[184:187], v[100:103], v[60:63]
    ds_read_b128 v[236:239], v16 offset:1216
    v_mfma_f32_16x16x32_bf16 v[48:51], v[96:99], v[164:167], v[48:51]
    ds_read_b64 v[240:241], v14 offset:3264
    v_mfma_f32_16x16x32_bf16 v[52:55], v[96:99], v[172:175], v[52:55]
    ds_read_b64 v[242:243], v14 offset:3272
    v_mfma_f32_16x16x32_bf16 v[56:59], v[96:99], v[180:183], v[56:59]
    ds_read_b128 v[244:247], v16 offset:704
    buffer_load_dwordx4 v[68:71], v10, s[68:71], s38 offen offset:0 sc1
    v_mfma_f32_16x16x32_bf16 v[60:63], v[96:99], v[188:191], v[60:63]
    ds_read_b64 v[248:249], v14 offset:3776
    s_waitcnt lgkmcnt(15)
    v_mfma_f32_16x16x32_bf16 v[52:55], v[160:163], v[108:111], v[52:55]
    buffer_store_dword a224, v31, s[68:71], s6 offen offset:8 sc1
    v_mfma_f32_16x16x32_bf16 v[56:59], v[168:171], v[108:111], v[56:59]
    ds_read_b64 v[250:251], v14 offset:3784
    v_mfma_f32_16x16x32_bf16 v[60:63], v[176:179], v[108:111], v[60:63]
    ds_read_b128 v[252:255], v16 offset:192
    buffer_load_dwordx4 v[72:75], v10, s[68:71], s39 offen offset:0 sc1
    v_mfma_f32_16x16x32_bf16 v[52:55], v[104:107], v[164:167], v[52:55]
    v_mfma_f32_16x16x32_bf16 v[56:59], v[104:107], v[172:175], v[56:59]
    v_mfma_f32_16x16x32_bf16 v[60:63], v[104:107], v[180:183], v[60:63]
    v_mfma_f32_16x16x32_bf16 v[56:59], v[160:163], v[116:119], v[56:59]
    buffer_load_dwordx4 v[76:79], v10, s[68:71], s40 offen offset:0 sc1
    v_mfma_f32_16x16x32_bf16 v[60:63], v[168:171], v[116:119], v[60:63]
    v_mfma_f32_16x16x32_bf16 v[56:59], v[112:115], v[164:167], v[56:59]
    v_mfma_f32_16x16x32_bf16 v[60:63], v[112:115], v[172:175], v[60:63]
    v_mfma_f32_16x16x32_bf16 v[60:63], v[160:163], v[124:127], v[60:63]
    buffer_load_dwordx4 v[80:83], v10, s[68:71], s41 offen offset:0 sc1
    v_mfma_f32_16x16x32_bf16 v[60:63], v[120:123], v[164:167], v[60:63]
    v_mfma_f32_16x16x32_bf16 v[32:35], v[192:195], v[196:199], v[32:35]
    v_mfma_f32_16x16x32_bf16 v[36:39], v[192:195], v[204:207], v[36:39]
    ds_read_b64 v[176:177], v17 offset:1536
    v_mfma_f32_16x16x32_bf16 v[36:39], v[200:203], v[196:199], v[36:39]
    buffer_load_dwordx4 v[84:87], v10, s[68:71], s42 offen offset:0 sc1
    v_mfma_f32_16x16x32_bf16 v[40:43], v[200:203], v[204:207], v[40:43]
    ds_read_b64 v[178:179], v17 offset:1024
    s_waitcnt lgkmcnt(15)
    v_mfma_f32_16x16x32_bf16 v[40:43], v[192:195], v[212:215], v[40:43]
    ds_read_b64 v[180:181], v17 offset:512
    v_mfma_f32_16x16x32_bf16 v[44:47], v[200:203], v[212:215], v[44:47]
    ds_read_b64 v[182:183], v17 offset:0
    v_mfma_f32_16x16x32_bf16 v[40:43], v[208:211], v[196:199], v[40:43]
    buffer_load_dwordx4 v[88:91], v10, s[68:71], s37 offen offset:1024 sc1
    v_mfma_f32_16x16x32_bf16 v[44:47], v[208:211], v[204:207], v[44:47]
    v_lshlrev_b32 v0, 16, v0
    v_mfma_f32_16x16x32_bf16 v[48:51], v[208:211], v[212:215], v[48:51]
    s_waitcnt lgkmcnt(4)
    s_barrier
    ds_read_b64_tr_b16 a[0:1], v28 offset:33024
    v_mfma_f32_16x16x32_bf16 v[44:47], v[192:195], v[220:223], v[44:47]
    ds_read_b64_tr_b16 a[2:3], v28 offset:34048
    v_mfma_f32_16x16x32_bf16 v[48:51], v[200:203], v[220:223], v[48:51]
    buffer_load_dwordx4 v[92:95], v10, s[68:71], s38 offen offset:1024 sc1
    v_mfma_f32_16x16x32_bf16 v[52:55], v[208:211], v[220:223], v[52:55]
    ds_read_b64_tr_b16 a[4:5], v29 offset:33024
    v_mfma_f32_16x16x32_bf16 v[44:47], v[216:219], v[196:199], v[44:47]
    ds_read_b64_tr_b16 a[6:7], v29 offset:34048
    v_mfma_f32_16x16x32_bf16 v[48:51], v[216:219], v[204:207], v[48:51]
    ds_read_b64_tr_b16 a[32:33], v26 offset:32768
    v_mfma_f32_16x16x32_bf16 v[52:55], v[216:219], v[212:215], v[52:55]
    buffer_load_dwordx4 v[96:99], v10, s[68:71], s39 offen offset:1024 sc1
    v_mfma_f32_16x16x32_bf16 v[56:59], v[216:219], v[220:223], v[56:59]
    ds_read_b64_tr_b16 a[34:35], v26 offset:33792
    v_mfma_f32_16x16x32_bf16 v[48:51], v[192:195], v[228:231], v[48:51]
    ds_read_b64_tr_b16 a[36:37], v27 offset:32768
    v_mfma_f32_16x16x32_bf16 v[52:55], v[200:203], v[228:231], v[52:55]
    ds_read_b64_tr_b16 a[38:39], v27 offset:33792
    v_mfma_f32_16x16x32_bf16 v[56:59], v[208:211], v[228:231], v[56:59]
    buffer_load_dwordx4 v[100:103], v10, s[68:71], s40 offen offset:1024 sc1
    v_mfma_f32_16x16x32_bf16 v[60:63], v[216:219], v[228:231], v[60:63]
    ds_read_b64_tr_b16 a[64:65], v26 offset:49152
    v_mfma_f32_16x16x32_bf16 v[48:51], v[224:227], v[196:199], v[48:51]
    ds_read_b64_tr_b16 a[66:67], v26 offset:50176
    v_mfma_f32_16x16x32_bf16 v[52:55], v[224:227], v[204:207], v[52:55]
    ds_read_b64_tr_b16 a[68:69], v27 offset:49152
    v_mfma_f32_16x16x32_bf16 v[56:59], v[224:227], v[212:215], v[56:59]
    buffer_load_dwordx4 v[104:107], v10, s[68:71], s41 offen offset:1024 sc1
    v_mfma_f32_16x16x32_bf16 v[60:63], v[224:227], v[220:223], v[60:63]
    ds_read_b64_tr_b16 a[70:71], v27 offset:50176
    v_mfma_f32_16x16x32_bf16 v[52:55], v[192:195], v[236:239], v[52:55]
    ds_read_b64_tr_b16 a[96:97], v28 offset:0
    v_mfma_f32_16x16x32_bf16 v[56:59], v[200:203], v[236:239], v[56:59]
    ds_read_b64_tr_b16 a[98:99], v28 offset:1024
    v_mfma_f32_16x16x32_bf16 v[60:63], v[208:211], v[236:239], v[60:63]
    buffer_load_dwordx4 v[108:111], v10, s[68:71], s42 offen offset:1024 sc1
    v_mfma_f32_16x16x32_bf16 v[52:55], v[232:235], v[196:199], v[52:55]
    ds_read_b64_tr_b16 a[100:101], v29 offset:0
    v_mfma_f32_16x16x32_bf16 v[56:59], v[232:235], v[204:207], v[56:59]
    ds_read_b64_tr_b16 a[102:103], v29 offset:1024
    v_mfma_f32_16x16x32_bf16 v[60:63], v[232:235], v[212:215], v[60:63]
    s_waitcnt lgkmcnt(15)
    v_and_b32 v160, 0xffff0000, v177
    v_mfma_f32_16x16x32_bf16 v[56:59], v[192:195], v[244:247], v[56:59]
    v_lshlrev_b32 v161, 16, v177
    v_mfma_f32_16x16x32_bf16 v[60:63], v[200:203], v[244:247], v[60:63]
    v_and_b32 v162, 0xffff0000, v176
    v_mfma_f32_16x16x32_bf16 v[56:59], v[240:243], v[196:199], v[56:59]
    v_lshlrev_b32 v163, 16, v176
    v_mfma_f32_16x16x32_bf16 v[60:63], v[240:243], v[204:207], v[60:63]
    v_and_b32 v164, 0xffff0000, v179
    v_mfma_f32_16x16x32_bf16 v[60:63], v[192:195], v[252:255], v[60:63]
    v_lshlrev_b32 v165, 16, v179
    v_mfma_f32_16x16x32_bf16 v[60:63], v[248:251], v[196:199], v[60:63]
    v_and_b32 v166, 0xffff0000, v178
    v_lshlrev_b32 v167, 16, v178
    v_and_b32 v168, 0xffff0000, v181
    v_lshlrev_b32 v169, 16, v181
    v_and_b32 v170, 0xffff0000, v180
    v_lshlrev_b32 v171, 16, v180
    v_and_b32 v172, 0xffff0000, v183
    v_lshlrev_b32 v173, 16, v183
    v_and_b32 v174, 0xffff0000, v182
    v_lshlrev_b32 v175, 16, v182
    v_add_u32 v18, s81, v30
    v_xor_b32 v20, 4096, v18
    v_add_u32 v22, 114944, v18
    v_add_u32 v23, 114944, v20
    v_mov_b32 v178, s78
    v_mov_b32 v179, s78
    v_mov_b32 v182, s78
    v_mov_b32 v183, s78
    v_mov_b32 v186, s78
    v_mov_b32 v187, s78
    v_mov_b32 v190, s78
    v_mov_b32 v191, s78
    s_cmp_eq_u32 s79, 0
    s_cbranch_scc0 L_cx1
    ds_write_b128 v22, v[48:51] offset:0
    v_fma_f32 v224, v160, v0, v32
    v_fma_f32 v225, v161, v0, v33
    v_fma_f32 v226, v162, v0, v34
    v_fma_f32 v227, v163, v0, v35
    ds_write_b128 v22, v[52:55] offset:1024
    v_fma_f32 v228, v164, v0, v36
    v_fma_f32 v229, v165, v0, v37
    v_fma_f32 v230, v166, v0, v38
    v_fma_f32 v231, v167, v0, v39
    ds_write_b128 v22, v[56:59] offset:2048
    v_fma_f32 v232, v168, v0, v40
    v_fma_f32 v233, v169, v0, v41
    v_fma_f32 v234, v170, v0, v42
    v_fma_f32 v235, v171, v0, v43
    ds_write_b128 v22, v[60:63] offset:3072
    v_fma_f32 v236, v172, v0, v44
    v_fma_f32 v237, v173, v0, v45
    v_fma_f32 v238, v174, v0, v46
    v_fma_f32 v239, v175, v0, v47
    s_branch L_cx2
L_cx1:
    ds_write_b128 v22, v[32:35] offset:0
    v_fma_f32 v224, v160, v0, v48
    v_fma_f32 v225, v161, v0, v49
    v_fma_f32 v226, v162, v0, v50
    v_fma_f32 v227, v163, v0, v51
    ds_write_b128 v22, v[36:39] offset:1024
    v_fma_f32 v228, v164, v0, v52
    v_fma_f32 v229, v165, v0, v53
    v_fma_f32 v230, v166, v0, v54
    v_fma_f32 v231, v167, v0, v55
    ds_write_b128 v22, v[40:43] offset:2048
    v_fma_f32 v232, v168, v0, v56
    v_fma_f32 v233, v169, v0, v57
    v_fma_f32 v234, v170, v0, v58
    v_fma_f32 v235, v171, v0, v59
    ds_write_b128 v22, v[44:47] offset:3072
    v_fma_f32 v236, v172, v0, v60
    v_fma_f32 v237, v173, v0, v61
    v_fma_f32 v238, v174, v0, v62
    v_fma_f32 v239, v175, v0, v63
L_cx2:
    v_accvgpr_read_b32 v24, a236
    s_waitcnt lgkmcnt(0)
    s_barrier
    ds_read_b128 v[240:243], v23 offset:0
    ds_read_b128 v[244:247], v23 offset:1024
    ds_read_b128 v[248:251], v23 offset:2048
    ds_read_b128 v[252:255], v23 offset:3072
    buffer_load_dword v13, v21, s[68:71], s28 offen offset:8 sc1
    s_waitcnt lgkmcnt(3)
    v_add_f32 v224, v224, v240
    v_add_f32 v225, v225, v241
    v_add_f32 v226, v226, v242
    v_add_f32 v227, v227, v243
    v_cvt_pk_bf16_f32 v176, v224, v225
    v_cvt_pk_bf16_f32 v177, v226, v227
    buffer_store_dwordx4 v[176:179], v24, s[68:71], s16 offen offset:0 sc1
    s_waitcnt lgkmcnt(2)
    v_add_f32 v228, v228, v244
    v_add_f32 v229, v229, v245
    v_add_f32 v230, v230, v246
    v_add_f32 v231, v231, v247
    v_cvt_pk_bf16_f32 v180, v228, v229
    v_cvt_pk_bf16_f32 v181, v230, v231
    buffer_store_dwordx4 v[180:183], v24, s[68:71], s16 offen offset:1024 sc1
    s_waitcnt lgkmcnt(1)
    v_add_f32 v232, v232, v248
    v_add_f32 v233, v233, v249
    v_add_f32 v234, v234, v250
    v_add_f32 v235, v235, v251
    v_cvt_pk_bf16_f32 v184, v232, v233
    v_cvt_pk_bf16_f32 v185, v234, v235
    buffer_store_dwordx4 v[184:187], v24, s[68:71], s16 offen offset:2048 sc1
    s_waitcnt lgkmcnt(0)
    v_add_f32 v236, v236, v252
    v_add_f32 v237, v237, v253
    v_add_f32 v238, v238, v254
    v_add_f32 v239, v239, v255
    v_cvt_pk_bf16_f32 v188, v236, v237
    v_cvt_pk_bf16_f32 v189, v238, v239
    buffer_store_dwordx4 v[188:191], v24, s[68:71], s16 offen offset:3072 sc1
    v_mfma_f32_32x32x16_bf16 v[192:207], a[0:3], v[136:139], 0
    ds_read_b64_tr_b16 a[128:129], v28 offset:16384
    ds_read_b64_tr_b16 a[130:131], v28 offset:17408
    v_mfma_f32_32x32x16_bf16 v[208:223], a[4:7], v[136:139], 0
    ds_read_b64_tr_b16 a[132:133], v29 offset:16384
    ds_read_b64_tr_b16 a[134:135], v29 offset:17408
    s_waitcnt vmcnt(17)
    v_mfma_f32_32x32x16_bf16 v[192:207], a[32:35], v[64:67], v[192:207]
    ds_read_b64_tr_b16 a[160:161], v26 offset:0
    ds_read_b64_tr_b16 a[162:163], v26 offset:1024
    v_lshlrev_b32 v48, 16, v2
    v_and_b32 v49, 0xffff0000, v2
    v_lshlrev_b32 v50, 16, v3
    v_mfma_f32_32x32x16_bf16 v[208:223], a[36:39], v[64:67], v[208:223]
    ds_read_b64_tr_b16 a[164:165], v27 offset:0
    ds_read_b64_tr_b16 a[166:167], v27 offset:1024
    v_and_b32 v51, 0xffff0000, v3
    v_lshlrev_b32 v52, 16, v4
    s_waitcnt vmcnt(16)
    v_mfma_f32_32x32x16_bf16 v[192:207], a[64:67], v[68:71], v[192:207]
    ds_read_b64_tr_b16 a[192:193], v26 offset:16384
    ds_read_b64_tr_b16 a[194:195], v26 offset:17408
    s_waitcnt vmcnt(4)
    v_cmp_ne_u32 vcc, s78, v13
    s_cbranch_vccnz L_slow_H2
L_res_H2:
    v_mfma_f32_32x32x16_bf16 v[208:223], a[68:71], v[68:71], v[208:223]
    ds_read_b64_tr_b16 a[196:197], v27 offset:16384
    ds_read_b64_tr_b16 a[198:199], v27 offset:17408
    buffer_load_dwordx4 v[112:115], v10, s[68:71], s37 offen offset:2048 sc1
    v_mfma_f32_32x32x16_bf16 v[192:207], a[96:99], v[72:75], v[192:207]
    ds_read_b64_tr_b16 a[8:9], v28 offset:35072
    ds_read_b64_tr_b16 a[10:11], v28 offset:36096
    buffer_load_dwordx4 v[116:119], v10, s[68:71], s38 offen offset:2048 sc1
    v_and_b32 v53, 0xffff0000, v4
    v_mfma_f32_32x32x16_bf16 v[208:223], a[100:103], v[72:75], v[208:223]
    ds_read_b64_tr_b16 a[12:13], v29 offset:35072
    ds_read_b64_tr_b16 a[14:15], v29 offset:36096
    v_lshlrev_b32 v54, 16, v5
    v_and_b32 v55, 0xffff0000, v5
    s_waitcnt lgkmcnt(12)
    v_mfma_f32_32x32x16_bf16 v[192:207], a[128:131], v[76:79], v[192:207]
    ds_read_b64_tr_b16 a[40:41], v26 offset:34816
    ds_read_b64_tr_b16 a[42:43], v26 offset:35840
    buffer_load_dwordx4 v[120:123], v10, s[68:71], s39 offen offset:2048 sc1
    v_lshlrev_b32 v56, 16, v6
    v_mfma_f32_32x32x16_bf16 v[208:223], a[132:135], v[76:79], v[208:223]
    ds_read_b64_tr_b16 a[44:45], v27 offset:34816
    ds_read_b64_tr_b16 a[46:47], v27 offset:35840
    v_and_b32 v57, 0xffff0000, v6
    v_lshlrev_b32 v58, 16, v7
    v_and_b32 v16, 511, v30
    buffer_load_dwordx3 v[22:24], v16, s[68:71], s19 offen sc1
    s_waitcnt lgkmcnt(12)
    v_mfma_f32_32x32x16_bf16 v[192:207], a[160:163], v[80:83], v[192:207]
    ds_read_b64_tr_b16 a[72:73], v26 offset:51200
    ds_read_b64_tr_b16 a[74:75], v26 offset:52224
    buffer_load_dwordx4 v[124:127], v10, s[68:71], s40 offen offset:2048 sc1
    v_and_b32 v59, 0xffff0000, v7
    v_mfma_f32_32x32x16_bf16 v[208:223], a[164:167], v[80:83], v[208:223]
    ds_read_b64_tr_b16 a[76:77], v27 offset:51200
    ds_read_b64_tr_b16 a[78:79], v27 offset:52224
    v_lshlrev_b32 v60, 16, v8
    v_and_b32 v61, 0xffff0000, v8
    s_waitcnt lgkmcnt(12)
    v_mfma_f32_32x32x16_bf16 v[192:207], a[192:195], v[84:87], v[192:207]
    ds_read_b64_tr_b16 a[104:105], v28 offset:2048
    ds_read_b64_tr_b16 a[106:107], v28 offset:3072
    buffer_load_dwordx4 v[160:163], v10, s[68:71], s41 offen offset:2048 sc1
    v_lshlrev_b32 v62, 16, v9
    v_mfma_f32_32x32x16_bf16 v[208:223], a[196:199], v[84:87], v[208:223]
    ds_read_b64_tr_b16 a[108:109], v29 offset:2048
    ds_read_b64_tr_b16 a[110:111], v29 offset:3072
    buffer_load_dwordx4 v[164:167], v10, s[68:71], s42 offen offset:2048 sc1
    s_waitcnt lgkmcnt(12)
    v_mfma_f32_32x32x16_bf16 v[192:207], a[8:11], v[128:131], v[192:207]
    ds_read_b64_tr_b16 a[136:137], v28 offset:18432
    ds_read_b64_tr_b16 a[138:139], v28 offset:19456
    v_and_b32 v63, 0xffff0000, v9
    v_accvgpr_read_b32 v17, a239
    v_add_u32 v18, 131584, v17
    v_mfma_f32_32x32x16_bf16 v[208:223], a[12:15], v[128:131], v[208:223]
    ds_read_b64_tr_b16 a[140:141], v29 offset:18432
    ds_read_b64_tr_b16 a[142:143], v29 offset:19456
    buffer_load_dwordx4 v[168:171], v10, s[68:71], s37 offen offset:3072 sc1
    s_waitcnt lgkmcnt(12)
    v_mfma_f32_32x32x16_bf16 v[192:207], a[40:43], v[88:91], v[192:207]
    ds_read_b64_tr_b16 a[168:169], v26 offset:2048
    ds_read_b64_tr_b16 a[170:171], v26 offset:3072
    v_add_u32 v25, 131584, v20
    v_accvgpr_read_b32 v15, a238
    s_add_u32 s94, s18, 65536
    v_mfma_f32_32x32x16_bf16 v[208:223], a[44:47], v[88:91], v[208:223]
    ds_read_b64_tr_b16 a[172:173], v27 offset:2048
    ds_read_b64_tr_b16 a[174:175], v27 offset:3072
    buffer_load_dwordx4 v[172:175], v10, s[68:71], s38 offen offset:3072 sc1
    s_waitcnt lgkmcnt(12)
    v_mfma_f32_32x32x16_bf16 v[192:207], a[72:75], v[92:95], v[192:207]
    ds_read_b64_tr_b16 a[200:201], v26 offset:18432
    ds_read_b64_tr_b16 a[202:203], v26 offset:19456
    s_add_u32 s95, s18, 131072
    s_add_u32 s96, s18, 196608
    v_mfma_f32_32x32x16_bf16 v[208:223], a[76:79], v[92:95], v[208:223]
    ds_read_b64_tr_b16 a[204:205], v27 offset:18432
    ds_read_b64_tr_b16 a[206:207], v27 offset:19456
    buffer_load_dwordx4 v[64:67], v10, s[68:71], s39 offen offset:3072 sc1
    s_waitcnt lgkmcnt(12)
    v_mfma_f32_32x32x16_bf16 v[192:207], a[104:107], v[96:99], v[192:207]
    ds_read_b64_tr_b16 a[16:17], v28 offset:41216
    ds_read_b64_tr_b16 a[18:19], v28 offset:42240
    buffer_load_dwordx4 v[68:71], v10, s[68:71], s40 offen offset:3072 sc1
    v_mfma_f32_32x32x16_bf16 v[208:223], a[108:111], v[96:99], v[208:223]
    ds_read_b64_tr_b16 a[20:21], v29 offset:41216
    ds_read_b64_tr_b16 a[22:23], v29 offset:42240
    s_waitcnt lgkmcnt(12)
    v_mfma_f32_32x32x16_bf16 v[192:207], a[136:139], v[100:103], v[192:207]
    ds_read_b64_tr_b16 a[48:49], v26 offset:40960
    ds_read_b64_tr_b16 a[50:51], v26 offset:41984
    buffer_load_dwordx4 v[72:75], v10, s[68:71], s41 offen offset:3072 sc1
    v_mfma_f32_32x32x16_bf16 v[208:223], a[140:143], v[100:103], v[208:223]
    ds_read_b64_tr_b16 a[52:53], v27 offset:40960
    ds_read_b64_tr_b16 a[54:55], v27 offset:41984
    s_waitcnt lgkmcnt(12)
    v_mfma_f32_32x32x16_bf16 v[192:207], a[168:171], v[104:107], v[192:207]
    ds_read_b64_tr_b16 a[80:81], v26 offset:57344
    ds_read_b64_tr_b16 a[82:83], v26 offset:58368
    buffer_load_dwordx4 v[76:79], v10, s[68:71], s42 offen offset:3072 sc1
    v_mfma_f32_32x32x16_bf16 v[208:223], a[172:175], v[104:107], v[208:223]
    ds_read_b64_tr_b16 a[84:85], v27 offset:57344
    ds_read_b64_tr_b16 a[86:87], v27 offset:58368
    s_waitcnt lgkmcnt(12)
    v_mfma_f32_32x32x16_bf16 v[192:207], a[200:203], v[108:111], v[192:207]
    ds_read_b64_tr_b16 a[112:113], v28 offset:8192
    ds_read_b64_tr_b16 a[114:115], v28 offset:9216
    buffer_load_dwordx4 v[80:83], v11, s[68:71], s37 offen offset:0 sc1
    v_mfma_f32_32x32x16_bf16 v[208:223], a[204:207], v[108:111], v[208:223]
    ds_read_b64_tr_b16 a[116:117], v29 offset:8192
    ds_read_b64_tr_b16 a[118:119], v29 offset:9216
    buffer_load_dwordx4 v[84:87], v11, s[68:71], s38 offen offset:0 sc1
    s_waitcnt lgkmcnt(12)
    v_mfma_f32_32x32x16_bf16 v[192:207], a[16:19], v[140:143], v[192:207]
    ds_read_b64_tr_b16 a[144:145], v28 offset:24576
    ds_read_b64_tr_b16 a[146:147], v28 offset:25600
    v_mfma_f32_32x32x16_bf16 v[208:223], a[20:23], v[140:143], v[208:223]
    ds_read_b64_tr_b16 a[148:149], v29 offset:24576
    ds_read_b64_tr_b16 a[150:151], v29 offset:25600
    buffer_load_dwordx4 v[88:91], v11, s[68:71], s39 offen offset:0 sc1
    s_waitcnt vmcnt(15)
    s_waitcnt lgkmcnt(12)
    v_mfma_f32_32x32x16_bf16 v[192:207], a[48:51], v[112:115], v[192:207]
    ds_read_b64_tr_b16 a[176:177], v26 offset:8192
    ds_read_b64_tr_b16 a[178:179], v26 offset:9216
    v_mfma_f32_32x32x16_bf16 v[208:223], a[52:55], v[112:115], v[208:223]
    ds_read_b64_tr_b16 a[180:181], v27 offset:8192
    ds_read_b64_tr_b16 a[182:183], v27 offset:9216
    buffer_load_dwordx4 v[92:95], v11, s[68:71], s40 offen offset:0 sc1
    s_waitcnt vmcnt(15)
    s_waitcnt lgkmcnt(12)
    v_mfma_f32_32x32x16_bf16 v[192:207], a[80:83], v[116:119], v[192:207]
    ds_read_b64_tr_b16 a[208:209], v26 offset:24576
    ds_read_b64_tr_b16 a[210:211], v26 offset:25600
    v_mfma_f32_32x32x16_bf16 v[208:223], a[84:87], v[116:119], v[208:223]
    ds_read_b64_tr_b16 a[212:213], v27 offset:24576
    ds_read_b64_tr_b16 a[214:215], v27 offset:25600
    buffer_load_dwordx4 v[96:99], v11, s[68:71], s41 offen offset:0 sc1
    s_waitcnt vmcnt(15)
    s_waitcnt lgkmcnt(12)
    v_mfma_f32_32x32x16_bf16 v[192:207], a[112:115], v[120:123], v[192:207]
    ds_read_b64_tr_b16 a[24:25], v28 offset:43264
    ds_read_b64_tr_b16 a[26:27], v28 offset:44288
    buffer_load_dwordx4 v[100:103], v11, s[68:71], s42 offen offset:0 sc1
    v_mfma_f32_32x32x16_bf16 v[208:223], a[116:119], v[120:123], v[208:223]
    ds_read_b64_tr_b16 a[28:29], v29 offset:43264
    ds_read_b64_tr_b16 a[30:31], v29 offset:44288
    s_waitcnt vmcnt(14)
    s_waitcnt lgkmcnt(12)
    v_mfma_f32_32x32x16_bf16 v[192:207], a[144:147], v[124:127], v[192:207]
    ds_read_b64_tr_b16 a[56:57], v26 offset:43008
    ds_read_b64_tr_b16 a[58:59], v26 offset:44032
    buffer_load_dwordx4 v[104:107], v11, s[68:71], s37 offen offset:1024 sc1
    v_mfma_f32_32x32x16_bf16 v[208:223], a[148:151], v[124:127], v[208:223]
    ds_read_b64_tr_b16 a[60:61], v27 offset:43008
    ds_read_b64_tr_b16 a[62:63], v27 offset:44032
    s_waitcnt vmcnt(14)
    s_waitcnt lgkmcnt(12)
    v_mfma_f32_32x32x16_bf16 v[192:207], a[176:179], v[160:163], v[192:207]
    ds_read_b64_tr_b16 a[88:89], v26 offset:59392
    ds_read_b64_tr_b16 a[90:91], v26 offset:60416
    buffer_load_dwordx4 v[108:111], v11, s[68:71], s38 offen offset:1024 sc1
    v_mfma_f32_32x32x16_bf16 v[208:223], a[180:183], v[160:163], v[208:223]
    ds_read_b64_tr_b16 a[92:93], v27 offset:59392
    ds_read_b64_tr_b16 a[94:95], v27 offset:60416
    s_waitcnt vmcnt(14)
    s_waitcnt lgkmcnt(12)
    v_mfma_f32_32x32x16_bf16 v[192:207], a[208:211], v[164:167], v[192:207]
    ds_read_b64_tr_b16 a[120:121], v28 offset:10240
    ds_read_b64_tr_b16 a[122:123], v28 offset:11264
    buffer_load_dwordx4 v[112:115], v11, s[68:71], s39 offen offset:1024 sc1
    v_mfma_f32_32x32x16_bf16 v[208:223], a[212:215], v[164:167], v[208:223]
    ds_read_b64_tr_b16 a[124:125], v29 offset:10240
    ds_read_b64_tr_b16 a[126:127], v29 offset:11264
    buffer_load_dwordx4 v[116:119], v11, s[68:71], s40 offen offset:1024 sc1
    s_waitcnt lgkmcnt(12)
    v_mfma_f32_32x32x16_bf16 v[192:207], a[24:27], v[148:151], v[192:207]
    ds_read_b64_tr_b16 a[152:153], v28 offset:26624
    ds_read_b64_tr_b16 a[154:155], v28 offset:27648
    v_cmp_ne_u32 vcc, s78, v24
    s_cbranch_vccnz L_slow_S
L_res_S:
    v_mfma_f32_32x32x16_bf16 v[208:223], a[28:31], v[148:151], v[208:223]
    ds_read_b64_tr_b16 a[156:157], v29 offset:26624
    ds_read_b64_tr_b16 a[158:159], v29 offset:27648
    buffer_load_dwordx4 v[120:123], v11, s[68:71], s41 offen offset:1024 sc1
    s_waitcnt vmcnt(16)
    s_waitcnt lgkmcnt(12)
    v_mfma_f32_32x32x16_bf16 v[192:207], a[56:59], v[168:171], v[192:207]
    ds_read_b64_tr_b16 a[184:185], v26 offset:10240
    ds_read_b64_tr_b16 a[186:187], v26 offset:11264
    v_mul_f32 v22, v22, v23
    v_mul_f32 v24, v23, v23
    v_fma_f32 v32, v48, v23, -v22
    v_mfma_f32_32x32x16_bf16 v[208:223], a[60:63], v[168:171], v[208:223]
    ds_read_b64_tr_b16 a[188:189], v27 offset:10240
    ds_read_b64_tr_b16 a[190:191], v27 offset:11264
    buffer_load_dwordx4 v[124:127], v11, s[68:71], s42 offen offset:1024 sc1
    s_waitcnt vmcnt(16)
    s_waitcnt lgkmcnt(12)
    v_mfma_f32_32x32x16_bf16 v[192:207], a[88:91], v[172:175], v[192:207]
    ds_read_b64_tr_b16 a[216:217], v26 offset:26624
    ds_read_b64_tr_b16 a[218:219], v26 offset:27648
    v_fma_f32 v33, v49, v23, -v22
    v_fma_f32 v34, v50, v23, -v22
    v_fma_f32 v35, v51, v23, -v22
    v_mfma_f32_32x32x16_bf16 v[208:223], a[92:95], v[172:175], v[208:223]
    ds_read_b64_tr_b16 a[220:221], v27 offset:26624
    ds_read_b64_tr_b16 a[222:223], v27 offset:27648
    buffer_load_dwordx4 v[160:163], v11, s[68:71], s37 offen offset:2048 sc1
    s_waitcnt vmcnt(16)
    s_waitcnt lgkmcnt(12)
    v_mfma_f32_32x32x16_bf16 v[192:207], a[120:123], v[64:67], v[192:207]
    buffer_load_dwordx4 v[164:167], v11, s[68:71], s38 offen offset:2048 sc1
    v_fma_f32 v36, v52, v23, -v22
    v_fma_f32 v37, v53, v23, -v22
    v_fma_f32 v38, v54, v23, -v22
    v_mfma_f32_32x32x16_bf16 v[208:223], a[124:127], v[64:67], v[208:223]
    v_fma_f32 v39, v55, v23, -v22
    v_fma_f32 v40, v56, v23, -v22
    v_fma_f32 v41, v57, v23, -v22
    v_fma_f32 v42, v58, v23, -v22
    s_waitcnt vmcnt(16)
    s_waitcnt lgkmcnt(8)
    v_mfma_f32_32x32x16_bf16 v[192:207], a[152:155], v[68:71], v[192:207]
    buffer_load_dwordx4 v[168:171], v11, s[68:71], s39 offen offset:2048 sc1
    v_fma_f32 v43, v59, v23, -v22
    v_fma_f32 v44, v60, v23, -v22
    v_fma_f32 v45, v61, v23, -v22
    v_mfma_f32_32x32x16_bf16 v[208:223], a[156:159], v[68:71], v[208:223]
    v_fma_f32 v46, v62, v23, -v22
    v_fma_f32 v47, v63, v23, -v22
    v_lshrrev_b32 v14, 1, v30
    v_add_u32 v14, s17, v14
    s_waitcnt vmcnt(16)
    s_waitcnt lgkmcnt(4)
    v_mfma_f32_32x32x16_bf16 v[192:207], a[184:187], v[72:75], v[192:207]
    buffer_load_dwordx4 v[172:175], v11, s[68:71], s40 offen offset:2048 sc1
    v_mfma_f32_32x32x16_bf16 v[208:223], a[188:191], v[72:75], v[208:223]
    s_waitcnt vmcnt(16)
    s_waitcnt lgkmcnt(0)
    v_mfma_f32_32x32x16_bf16 v[192:207], a[216:219], v[76:79], v[192:207]
    buffer_load_dwordx4 v[64:67], v11, s[68:71], s41 offen offset:2048 sc1
    v_mfma_f32_32x32x16_bf16 v[208:223], a[220:223], v[76:79], v[208:223]
    buffer_load_dwordx4 v[68:71], v11, s[68:71], s42 offen offset:2048 sc1
    v_mfma_f32_32x32x16_bf16 v[224:239], a[0:3], v[152:155], 0
    v_mfma_f32_32x32x16_bf16 v[240:255], a[4:7], v[152:155], 0
    buffer_load_dwordx4 v[72:75], v11, s[68:71], s37 offen offset:3072 sc1
    s_waitcnt vmcnt(18)
    v_mfma_f32_32x32x16_bf16 v[224:239], a[32:35], v[80:83], v[224:239]
    s_nop 5
    ds_write_b128 v25, v[208:211] offset:0
    v_mfma_f32_32x32x16_bf16 v[240:255], a[36:39], v[80:83], v[240:255]
    buffer_load_dwordx4 v[76:79], v11, s[68:71], s38 offen offset:3072 sc1
    s_waitcnt vmcnt(18)
    v_mfma_f32_32x32x16_bf16 v[224:239], a[64:67], v[84:87], v[224:239]
    ds_write_b128 v25, v[212:215] offset:1024
    buffer_load_dwordx4 v[176:179], v15, s[68:71], s18 offen sc1
    v_mfma_f32_32x32x16_bf16 v[240:255], a[68:71], v[84:87], v[240:255]
    buffer_load_dwordx4 v[80:83], v11, s[68:71], s39 offen offset:3072 sc1
    s_waitcnt vmcnt(19)
    v_mfma_f32_32x32x16_bf16 v[224:239], a[96:99], v[88:91], v[224:239]
    buffer_load_dwordx4 v[84:87], v11, s[68:71], s40 offen offset:3072 sc1
    ds_write_b128 v25, v[216:219] offset:2048
    v_mfma_f32_32x32x16_bf16 v[240:255], a[100:103], v[88:91], v[240:255]
    buffer_load_dwordx4 v[180:183], v15, s[68:71], s94 offen sc1
    s_waitcnt vmcnt(20)
    v_mfma_f32_32x32x16_bf16 v[224:239], a[128:131], v[92:95], v[224:239]
    buffer_load_dwordx4 v[88:91], v11, s[68:71], s41 offen offset:3072 sc1
    ds_write_b128 v25, v[220:223] offset:3072
    v_mfma_f32_32x32x16_bf16 v[240:255], a[132:135], v[92:95], v[240:255]
    buffer_load_dwordx4 v[184:187], v15, s[68:71], s95 offen sc1
    s_waitcnt vmcnt(21)
    v_mfma_f32_32x32x16_bf16 v[224:239], a[160:163], v[96:99], v[224:239]
    s_waitcnt lgkmcnt(0)
    s_barrier
    buffer_load_dwordx4 v[92:95], v11, s[68:71], s42 offen offset:3072 sc1
    ds_read_b128 v[208:211], v18 offset:0
    ds_read_b128 v[212:215], v18 offset:512
    ds_read_b128 v[216:219], v18 offset:2048
    v_mfma_f32_32x32x16_bf16 v[240:255], a[164:167], v[96:99], v[240:255]
    ds_read_b128 v[220:223], v18 offset:2560
    v_permlane32_swap_b32 v192, v196
    buffer_load_dwordx4 v[188:191], v15, s[68:71], s96 offen sc1
    s_waitcnt vmcnt(22)
    v_mfma_f32_32x32x16_bf16 v[224:239], a[192:195], v[100:103], v[224:239]
    v_permlane32_swap_b32 v193, v197
    v_permlane32_swap_b32 v194, v198
    v_mfma_f32_32x32x16_bf16 v[240:255], a[196:199], v[100:103], v[240:255]
    v_permlane32_swap_b32 v195, v199
    v_permlane32_swap_b32 v200, v204
    v_mfma_f32_32x32x16_bf16 v[224:239], a[8:11], v[132:135], v[224:239]
    v_permlane32_swap_b32 v201, v205
    v_permlane32_swap_b32 v202, v206
    v_mfma_f32_32x32x16_bf16 v[240:255], a[12:15], v[132:135], v[240:255]
    v_permlane32_swap_b32 v203, v207
    s_waitcnt vmcnt(21)
    v_mfma_f32_32x32x16_bf16 v[224:239], a[40:43], v[104:107], v[224:239]
    v_mfma_f32_32x32x16_bf16 v[240:255], a[44:47], v[104:107], v[240:255]
    s_waitcnt lgkmcnt(0)
    v_add_f32 v192, v192, v208
    v_add_f32 v193, v193, v209
    v_add_f32 v194, v194, v210
    s_waitcnt vmcnt(20)
    v_mfma_f32_32x32x16_bf16 v[224:239], a[72:75], v[108:111], v[224:239]
    v_add_f32 v195, v195, v211
    v_add_f32 v196, v196, v212
    v_add_f32 v197, v197, v213
    v_add_f32 v198, v198, v214
    v_add_f32 v199, v199, v215
    v_mfma_f32_32x32x16_bf16 v[240:255], a[76:79], v[108:111], v[240:255]
    v_add_f32 v200, v200, v216
    v_add_f32 v201, v201, v217
    v_add_f32 v202, v202, v218
    v_add_f32 v203, v203, v219
    s_waitcnt vmcnt(19)
    v_mfma_f32_32x32x16_bf16 v[224:239], a[104:107], v[112:115], v[224:239]
    v_add_f32 v204, v204, v220
    v_add_f32 v205, v205, v221
    v_add_f32 v206, v206, v222
    v_add_f32 v207, v207, v223
    v_cvt_pk_bf16_f32 v208, v192, v193
    v_cvt_pk_bf16_f32 v209, v194, v195
    v_cvt_pk_bf16_f32 v210, v196, v197
    v_mov_b32 v211, s78
    buffer_store_dwordx4 v[208:211], v30, s[68:71], s23 offen offset:0 sc1
    v_mfma_f32_32x32x16_bf16 v[240:255], a[108:111], v[112:115], v[240:255]
    v_cvt_pk_bf16_f32 v212, v198, v199
    v_cvt_pk_bf16_f32 v213, v200, v201
    v_cvt_pk_bf16_f32 v214, v202, v203
    v_mov_b32 v215, s78
    buffer_store_dwordx4 v[212:215], v30, s[68:71], s23 offen offset:1024 sc1
    s_waitcnt vmcnt(20)
    v_mfma_f32_32x32x16_bf16 v[224:239], a[136:139], v[116:119], v[224:239]
    v_cvt_pk_bf16_f32 v216, v204, v205
    v_cvt_pk_bf16_f32 v217, v206, v207
    v_mov_b32 v219, s78
    buffer_store_dwordx4 v[216:219], v30, s[68:71], s23 offen offset:2048 sc1
    v_mfma_f32_32x32x16_bf16 v[240:255], a[140:143], v[116:119], v[240:255]
    s_waitcnt vmcnt(20)
    v_mfma_f32_32x32x16_bf16 v[224:239], a[168:171], v[120:123], v[224:239]
    v_mfma_f32_32x32x16_bf16 v[240:255], a[172:175], v[120:123], v[240:255]
    s_waitcnt vmcnt(19)
    v_mfma_f32_32x32x16_bf16 v[224:239], a[200:203], v[124:127], v[224:239]
    v_mfma_f32_32x32x16_bf16 v[240:255], a[204:207], v[124:127], v[240:255]
    v_mfma_f32_32x32x16_bf16 v[224:239], a[16:19], v[144:147], v[224:239]
    v_mfma_f32_32x32x16_bf16 v[240:255], a[20:23], v[144:147], v[240:255]
    s_waitcnt vmcnt(18)
    v_mfma_f32_32x32x16_bf16 v[224:239], a[48:51], v[160:163], v[224:239]
    v_mfma_f32_32x32x16_bf16 v[240:255], a[52:55], v[160:163], v[240:255]
    s_waitcnt vmcnt(17)
    v_mfma_f32_32x32x16_bf16 v[224:239], a[80:83], v[164:167], v[224:239]
    v_mfma_f32_32x32x16_bf16 v[240:255], a[84:87], v[164:167], v[240:255]
    s_waitcnt vmcnt(16)
    v_mfma_f32_32x32x16_bf16 v[224:239], a[112:115], v[168:171], v[224:239]
    s_waitcnt vmcnt(3)
    v_xor_b32 v179, s78, v178
    v_xor_b32 v183, s78, v182
    v_xor_b32 v187, s78, v186
    v_xor_b32 v191, s78, v190
    v_mfma_f32_32x32x16_bf16 v[240:255], a[116:119], v[168:171], v[240:255]
    v_or3_b32 v179, v179, v183, v187
    v_or_b32 v179, v179, v191
    v_cmp_ne_u32 vcc, 0, v179
    s_cbranch_vccnz L_slow_Z
L_res_Z:
    v_mfma_f32_32x32x16_bf16 v[224:239], a[144:147], v[172:175], v[224:239]
    ds_write_b64 v14, v[176:177] offset:0
    ds_write_b64 v14, v[180:181] offset:512
    v_mfma_f32_32x32x16_bf16 v[240:255], a[148:151], v[172:175], v[240:255]
    ds_write_b64 v14, v[184:185] offset:1024
    ds_write_b64 v14, v[188:189] offset:1536
    v_mfma_f32_32x32x16_bf16 v[224:239], a[176:179], v[64:67], v[224:239]
    v_accvgpr_read_b32 v16, a237
    s_waitcnt lgkmcnt(0)
    ds_read_b64_tr_b16 v[2:3], v16 offset:0
    ds_read_b64_tr_b16 v[4:5], v16 offset:256
    ds_read_b64_tr_b16 v[6:7], v16 offset:1024
    v_mfma_f32_32x32x16_bf16 v[240:255], a[180:183], v[64:67], v[240:255]
    ds_read_b64_tr_b16 v[8:9], v16 offset:1280
    s_waitcnt lgkmcnt(0)
    v_lshlrev_b32 v12, 16, v2
    v_fma_f32 v32, v32, v12, v48
    v_mfma_f32_32x32x16_bf16 v[224:239], a[208:211], v[68:71], v[224:239]
    v_and_b32 v0, 0xffff0000, v2
    v_fma_f32 v33, v33, v0, v49
    v_lshlrev_b32 v12, 16, v3
    v_fma_f32 v34, v34, v12, v50
    v_and_b32 v0, 0xffff0000, v3
    v_mfma_f32_32x32x16_bf16 v[240:255], a[212:215], v[68:71], v[240:255]
    v_fma_f32 v35, v35, v0, v51
    v_lshlrev_b32 v12, 16, v4
    v_fma_f32 v36, v36, v12, v52
    v_and_b32 v0, 0xffff0000, v4
    v_mfma_f32_32x32x16_bf16 v[224:239], a[24:27], v[156:159], v[224:239]
    v_fma_f32 v37, v37, v0, v53
    v_lshlrev_b32 v12, 16, v5
    v_fma_f32 v38, v38, v12, v54
    v_and_b32 v0, 0xffff0000, v5
    v_fma_f32 v39, v39, v0, v55
    v_mfma_f32_32x32x16_bf16 v[240:255], a[28:31], v[156:159], v[240:255]
    v_lshlrev_b32 v12, 16, v6
    v_fma_f32 v40, v40, v12, v56
    v_and_b32 v0, 0xffff0000, v6
    v_fma_f32 v41, v41, v0, v57
    v_mfma_f32_32x32x16_bf16 v[224:239], a[56:59], v[72:75], v[224:239]
    v_lshlrev_b32 v12, 16, v7
    v_fma_f32 v42, v42, v12, v58
    v_and_b32 v0, 0xffff0000, v7
    v_fma_f32 v43, v43, v0, v59
    v_lshlrev_b32 v12, 16, v8
    v_mfma_f32_32x32x16_bf16 v[240:255], a[60:63], v[72:75], v[240:255]
    v_fma_f32 v44, v44, v12, v60
    v_and_b32 v0, 0xffff0000, v8
    v_fma_f32 v45, v45, v0, v61
    v_lshlrev_b32 v12, 16, v9
    v_mfma_f32_32x32x16_bf16 v[224:239], a[88:91], v[76:79], v[224:239]
    v_fma_f32 v46, v46, v12, v62
    v_and_b32 v0, 0xffff0000, v9
    v_fma_f32 v47, v47, v0, v63
    v_mfma_f32_32x32x16_bf16 v[240:255], a[92:95], v[76:79], v[240:255]
    v_mfma_f32_32x32x16_bf16 v[224:239], a[120:123], v[80:83], v[224:239]
    buffer_load_dwordx4 v[192:195], v30, s[68:71], s24 offen offset:0 sc1
    v_mfma_f32_32x32x16_bf16 v[240:255], a[124:127], v[80:83], v[240:255]
    buffer_load_dwordx4 v[196:199], v30, s[68:71], s24 offen offset:1024 sc1
    v_mfma_f32_32x32x16_bf16 v[224:239], a[152:155], v[84:87], v[224:239]
    buffer_load_dwordx4 v[200:203], v30, s[68:71], s24 offen offset:2048 sc1
    v_mfma_f32_32x32x16_bf16 v[240:255], a[156:159], v[84:87], v[240:255]
    v_mfma_f32_32x32x16_bf16 v[224:239], a[184:187], v[88:91], v[224:239]
    v_mfma_f32_32x32x16_bf16 v[240:255], a[188:191], v[88:91], v[240:255]
    v_mfma_f32_32x32x16_bf16 v[224:239], a[216:219], v[92:95], v[224:239]
    v_mfma_f32_32x32x16_bf16 v[240:255], a[220:223], v[92:95], v[240:255]
    s_nop 7
    s_nop 3
    ds_write_b128 v20, v[240:243] offset:0
    ds_write_b128 v20, v[244:247] offset:1024
    ds_write_b128 v20, v[248:251] offset:2048
    ds_write_b128 v20, v[252:255] offset:3072
    v_permlane32_swap_b32 v224, v228
    v_permlane32_swap_b32 v225, v229
    v_permlane32_swap_b32 v226, v230
    v_permlane32_swap_b32 v227, v231
    v_permlane32_swap_b32 v232, v236
    v_permlane32_swap_b32 v233, v237
    v_permlane32_swap_b32 v234, v238
    v_permlane32_swap_b32 v235, v239
    s_waitcnt lgkmcnt(0)
    s_barrier
    ds_read_b128 v[64:67], v17 offset:0
    ds_read_b128 v[68:71], v17 offset:512
    ds_read_b128 v[72:75], v17 offset:2048
    ds_read_b128 v[76:79], v17 offset:2560
    s_waitcnt lgkmcnt(0)
    v_add_f32 v224, v224, v64
    v_add_f32 v225, v225, v65
    v_add_f32 v226, v226, v66
    v_add_f32 v227, v227, v67
    v_add_f32 v228, v228, v68
    v_add_f32 v229, v229, v69
    v_add_f32 v230, v230, v70
    v_add_f32 v231, v231, v71
    v_add_f32 v232, v232, v72
    v_add_f32 v233, v233, v73
    v_add_f32 v234, v234, v74
    v_add_f32 v235, v235, v75
    v_add_f32 v236, v236, v76
    v_add_f32 v237, v237, v77
    v_add_f32 v238, v238, v78
    v_add_f32 v239, v239, v79
    s_waitcnt vmcnt(0)
    v_xor_b32 v195, s78, v195
    v_xor_b32 v199, s78, v199
    v_xor_b32 v203, s78, v203
    v_or3_b32 v195, v195, v199, v203
    v_cmp_ne_u32 vcc, 0, v195
    s_cbranch_vccnz L_slow_P
L_res_P:
    v_lshlrev_b32 v208, 16, v192
    v_add_f32 v224, v224, v208
    v_fma_f32 v224, v224, v24, v32
    v_and_b32 v209, 0xffff0000, v192
    v_add_f32 v225, v225, v209
    v_fma_f32 v225, v225, v24, v33
    v_lshlrev_b32 v210, 16, v193
    v_add_f32 v226, v226, v210
    v_fma_f32 v226, v226, v24, v34
    v_and_b32 v211, 0xffff0000, v193
    v_add_f32 v227, v227, v211
    v_fma_f32 v227, v227, v24, v35
    v_lshlrev_b32 v212, 16, v194
    v_add_f32 v228, v228, v212
    v_fma_f32 v228, v228, v24, v36
    v_and_b32 v213, 0xffff0000, v194
    v_add_f32 v229, v229, v213
    v_fma_f32 v229, v229, v24, v37
    v_lshlrev_b32 v214, 16, v196
    v_add_f32 v230, v230, v214
    v_fma_f32 v230, v230, v24, v38
    v_and_b32 v215, 0xffff0000, v196
    v_add_f32 v231, v231, v215
    v_fma_f32 v231, v231, v24, v39
    v_cvt_pk_bf16_f32 v80, v224, v225
    v_cvt_pk_bf16_f32 v81, v226, v227
    v_cvt_pk_bf16_f32 v82, v228, v229
    v_cvt_pk_bf16_f32 v83, v230, v231
    buffer_store_dwordx4 v[80:83], v19, s[64:67], 0 offen offset:0
    v_lshlrev_b32 v216, 16, v197
    v_add_f32 v232, v232, v216
    v_fma_f32 v232, v232, v24, v40
    v_and_b32 v217, 0xffff0000, v197
    v_add_f32 v233, v233, v217
    v_fma_f32 v233, v233, v24, v41
    v_lshlrev_b32 v218, 16, v198
    v_add_f32 v234, v234, v218
    v_fma_f32 v234, v234, v24, v42
    v_and_b32 v219, 0xffff0000, v198
    v_add_f32 v235, v235, v219
    v_fma_f32 v235, v235, v24, v43
    v_lshlrev_b32 v220, 16, v200
    v_add_f32 v236, v236, v220
    v_fma_f32 v236, v236, v24, v44
    v_and_b32 v221, 0xffff0000, v200
    v_add_f32 v237, v237, v221
    v_fma_f32 v237, v237, v24, v45
    v_lshlrev_b32 v222, 16, v201
    v_add_f32 v238, v238, v222
    v_fma_f32 v238, v238, v24, v46
    v_and_b32 v223, 0xffff0000, v201
    v_add_f32 v239, v239, v223
    v_fma_f32 v239, v239, v24, v47
    v_cvt_pk_bf16_f32 v84, v232, v233
    v_cvt_pk_bf16_f32 v85, v234, v235
    v_cvt_pk_bf16_f32 v86, v236, v237
    v_cvt_pk_bf16_f32 v87, v238, v239
    buffer_store_dwordx4 v[84:87], v19, s[64:67], 0 offen offset:32
    s_endpgm
L_slow_C:
    s_mov_b32 s86, 0
L_spin_C:
    s_sleep 4
    buffer_load_dwordx4 v[32:35], v58, s[68:71], s12 offen offset:0 sc1
    buffer_load_dwordx4 v[36:39], v58, s[68:71], s12 offen offset:512 sc1
    buffer_load_dwordx2 v[48:49], v59, s[68:71], s13 offen sc1
    buffer_load_dwordx2 v[52:53], v59, s[68:71], s29 offen sc1
    s_add_u32 s86, s86, 1
    s_waitcnt vmcnt(0)
    v_xor_b32 v4, s78, v35
    v_xor_b32 v5, s78, v39
    v_xor_b32 v8, s78, v49
    v_or3_b32 v4, v4, v5, v8
    v_xor_b32 v5, s78, v53
    v_or_b32 v4, v4, v5
    v_cmp_ne_u32 vcc, 0, v4
    s_cmp_lt_u32 s86, 100000
    s_cbranch_scc0 L_res_C
    s_cbranch_vccnz L_spin_C
    s_branch L_res_C
L_slow_C2:
    s_mov_b32 s86, 0
L_spin_C2:
    s_sleep 4
    buffer_load_dwordx4 v[40:43], v58, s[68:71], s12 offen offset:2048 sc1
    buffer_load_dwordx4 v[44:47], v58, s[68:71], s12 offen offset:2560 sc1
    s_add_u32 s86, s86, 1
    s_waitcnt vmcnt(0)
    v_xor_b32 v4, s78, v43
    v_xor_b32 v5, s78, v47
    v_or_b32 v4, v4, v5
    v_cmp_ne_u32 vcc, 0, v4
    s_cmp_lt_u32 s86, 100000
    s_cbranch_scc0 L_res_C2
    s_cbranch_vccnz L_spin_C2
    s_branch L_res_C2
L_slow_K:
    s_mov_b32 s86, 0
L_spin_K:
    s_sleep 4
    buffer_load_dword v56, v57, s[68:71], s27 offen sc1
    s_add_u32 s86, s86, 1
    s_waitcnt vmcnt(0)
    v_cmp_ne_u32 vcc, s78, v56
    s_cmp_lt_u32 s86, 100000
    s_cbranch_scc0 L_res_K
    s_cbranch_vccnz L_spin_K
    s_branch L_res_K
L_slow_H:
    s_mov_b32 s86, 0
L_spin_H:
    s_sleep 4
    buffer_load_dword v13, v21, s[68:71], s28 offen offset:0 sc1
    s_add_u32 s86, s86, 1
    s_waitcnt vmcnt(0)
    v_cmp_ne_u32 vcc, s78, v13
    s_cmp_lt_u32 s86, 100000
    s_cbranch_scc0 L_res_H
    s_cbranch_vccnz L_spin_H
    s_branch L_res_H
L_slow_H2:
    s_mov_b32 s86, 0
L_spin_H2:
    s_sleep 4
    buffer_load_dword v13, v21, s[68:71], s28 offen offset:8 sc1
    s_add_u32 s86, s86, 1
    s_waitcnt vmcnt(0)
    v_cmp_ne_u32 vcc, s78, v13
    s_cmp_lt_u32 s86, 100000
    s_cbranch_scc0 L_res_H2
    s_cbranch_vccnz L_spin_H2
    s_branch L_res_H2
L_slow_S:
    s_mov_b32 s86, 0
L_spin_S:
    s_sleep 4
    buffer_load_dwordx3 v[22:24], v16, s[68:71], s19 offen sc1
    s_add_u32 s86, s86, 1
    s_waitcnt vmcnt(0)
    v_cmp_ne_u32 vcc, s78, v24
    s_cmp_lt_u32 s86, 100000
    s_cbranch_scc0 L_res_S
    s_cbranch_vccnz L_spin_S
    s_branch L_res_S
L_slow_Z:
    s_mov_b32 s86, 0
L_spin_Z:
    s_sleep 4
    buffer_load_dwordx4 v[176:179], v15, s[68:71], s18 offen sc1
    buffer_load_dwordx4 v[180:183], v15, s[68:71], s94 offen sc1
    buffer_load_dwordx4 v[184:187], v15, s[68:71], s95 offen sc1
    buffer_load_dwordx4 v[188:191], v15, s[68:71], s96 offen sc1
    s_add_u32 s86, s86, 1
    s_waitcnt vmcnt(0)
    v_xor_b32 v179, s78, v178
    v_xor_b32 v183, s78, v182
    v_xor_b32 v187, s78, v186
    v_xor_b32 v191, s78, v190
    v_or3_b32 v179, v179, v183, v187
    v_or_b32 v179, v179, v191
    v_cmp_ne_u32 vcc, 0, v179
    s_cmp_lt_u32 s86, 100000
    s_cbranch_scc0 L_res_Z
    s_cbranch_vccnz L_spin_Z
    s_branch L_res_Z
L_slow_P:
    s_mov_b32 s86, 0
L_spin_P:
    s_sleep 4
    buffer_load_dwordx4 v[192:195], v30, s[68:71], s24 offen offset:0 sc1
    buffer_load_dwordx4 v[196:199], v30, s[68:71], s24 offen offset:1024 sc1
    buffer_load_dwordx4 v[200:203], v30, s[68:71], s24 offen offset:2048 sc1
    s_add_u32 s86, s86, 1
    s_waitcnt vmcnt(0)
    v_xor_b32 v195, s78, v195
    v_xor_b32 v199, s78, v199
    v_xor_b32 v203, s78, v203
    v_or3_b32 v195, v195, v199, v203
    v_cmp_ne_u32 vcc, 0, v195
    s_cmp_lt_u32 s86, 100000
    s_cbranch_scc0 L_res_P
    s_cbranch_vccnz L_spin_P
    s_branch L_res_P
L_end_of_main:
L_helper:
    s_waitcnt lgkmcnt(0)
    s_mov_b32 s32, s4
    s_mov_b32 s33, s5
    s_mov_b32 s34, 1835008
    s_mov_b32 s35, 0x00020000
    s_mov_b32 s68, s28
    s_mov_b32 s69, s29
    s_mov_b32 s70, 19398656
    s_mov_b32 s71, 0x00020000
    s_and_b32 s90, s2, 7
    s_lshr_b32 s91, s2, 3
    s_lshl_b32 s75, s90, 2
    s_add_u32 s75, s75, s91
    s_lshr_b32 s77, s90, 1
    s_lshl_b32 s77, s77, 2
    s_add_u32 s77, s77, s91
    s_and_b32 s90, s90, 1
    s_mul_i32 s74, s90, 7
    s_add_u32 s74, s74, s77
    s_cmp_ge_u32 s77, 7
    s_cselect_b32 s56, s20, s18
    s_cselect_b32 s57, s21, s19
    s_cselect_b32 s73, 1, 0
    s_cselect_b32 s90, 7, 0
    s_sub_u32 s74, s74, s90
    s_mov_b32 s58, 1605632
    s_mov_b32 s59, 0x00020000
    s_cmp_ge_u32 s77, 14
    s_cselect_b32 s81, 0x40000000, 0
    s_lshl_b32 s90, s75, 2
    s_add_u32 s90, s90, s72
    s_mul_i32 s90, s90, 14336
    s_add_u32 s91, s90, 7168
    v_lshrrev_b32 v2, 3, v1
    v_mul_u32_u24 v2, 896, v2
    v_and_b32 v3, 7, v1
    v_lshl_add_u32 v2, v3, 4, v2
    s_getpc_b64 s[92:93]
L_touch_base2:
    s_sub_u32 s92, s92, L_touch_base2-L_main
    s_subb_u32 s93, s93, 0
    s_lshr_b32 s94, s2, 3
    s_lshl_b32 s94, s94, 13
    v_lshrrev_b32 v6, 2, v0
    v_lshlrev_b32 v6, 7, v6
    v_add_u32 v6, s94, v6
    v_min_u32 v6, L_end_of_code-L_main-4, v6
    global_load_dword v8, v6, s[92:93]
    s_mov_b32 s94, 13336576
    v_mov_b32 v6, 0
    buffer_load_dword v7, v6, s[68:71], s94 offen sc1
    v_lshrrev_b32 v4, 3, v0
    v_mul_u32_u24 v4, 3584, v4
    v_and_b32 v5, 7, v0
    v_lshl_add_u32 v4, v5, 4, v4
    s_lshl_b32 s93, s74, 8
    s_add_u32 s93, s93, s81
    s_mov_b32 s60, s22
    s_mov_b32 s61, s23
    s_mov_b32 s62, 1605632
    s_mov_b32 s63, 0x00020000
    s_mov_b32 s82, 0x3f803f80
    s_mov_b32 s83, 0x00003f80
    s_mov_b32 s84, 0x3f800000
    s_add_u32 s96, s93, 0
    buffer_load_dwordx4 v[128:131], v4, s[56:59], s96 offen
    s_add_u32 s96, s93, 114688
    buffer_load_dwordx4 v[132:135], v4, s[56:59], s96 offen
    s_add_u32 s96, s93, 229376
    buffer_load_dwordx4 v[136:139], v4, s[56:59], s96 offen
    s_add_u32 s96, s93, 344064
    buffer_load_dwordx4 v[140:143], v4, s[56:59], s96 offen
    s_add_u32 s96, s93, 458752
    buffer_load_dwordx4 v[144:147], v4, s[56:59], s96 offen
    s_add_u32 s96, s93, 573440
    buffer_load_dwordx4 v[148:151], v4, s[56:59], s96 offen
    s_add_u32 s96, s93, 688128
    buffer_load_dwordx4 v[152:155], v4, s[56:59], s96 offen
    s_add_u32 s96, s93, 802816
    buffer_load_dwordx4 v[156:159], v4, s[56:59], s96 offen
    s_add_u32 s96, s93, 917504
    buffer_load_dwordx4 v[160:163], v4, s[56:59], s96 offen
    s_add_u32 s96, s93, 1032192
    buffer_load_dwordx4 v[164:167], v4, s[56:59], s96 offen
    s_add_u32 s96, s93, 1146880
    buffer_load_dwordx4 v[168:171], v4, s[56:59], s96 offen
    s_add_u32 s96, s93, 1261568
    buffer_load_dwordx4 v[172:175], v4, s[56:59], s96 offen
    s_add_u32 s96, s93, 1376256
    buffer_load_dwordx4 v[176:179], v4, s[56:59], s96 offen
    s_add_u32 s96, s93, 1490944
    buffer_load_dwordx4 v[180:183], v4, s[56:59], s96 offen
    v_lshlrev_b32 v10, 5, v0
    v_lshlrev_b32 v11, 2, v1
    v_lshrrev_b32 v12, 4, v1
    v_lshlrev_b32 v12, 9, v12
    v_and_b32 v5, 15, v1
    v_lshl_add_u32 v12, v5, 4, v12
    s_lshl_b32 s87, s74, 12
    s_lshl_b32 s94, s73, 8
    s_add_u32 s87, s87, s94
    s_add_u32 s87, s87, 12861440
    s_cmp_eq_u32 s72, 0
    s_cselect_b32 s94, s81, 0x40000000
    s_add_u32 s87, s87, s94
    v_mov_b32 v108, 0
    v_mov_b32 v109, 0
    v_mov_b32 v110, 0
    v_mov_b32 v111, 0
    v_mov_b32 v112, 0
    v_mov_b32 v113, 0
    v_mov_b32 v114, 0
    v_mov_b32 v115, 0
    buffer_load_dwordx4 v[32:35], v2, s[32:35], s90 offen offset:0
    s_waitcnt vmcnt(14)
    v_dot2c_f32_bf16 v108, s83, v128
    v_dot2c_f32_bf16 v109, s84, v128
    v_dot2c_f32_bf16 v110, s83, v129
    v_dot2c_f32_bf16 v111, s84, v129
    v_dot2c_f32_bf16 v112, s83, v130
    v_dot2c_f32_bf16 v113, s84, v130
    v_dot2c_f32_bf16 v114, s83, v131
    v_dot2c_f32_bf16 v115, s84, v131
    buffer_load_dwordx4 v[36:39], v2, s[32:35], s90 offen offset:128
    s_waitcnt vmcnt(14)
    v_dot2c_f32_bf16 v108, s83, v132
    v_dot2c_f32_bf16 v109, s84, v132
    v_dot2c_f32_bf16 v110, s83, v133
    v_dot2c_f32_bf16 v111, s84, v133
    v_dot2c_f32_bf16 v112, s83, v134
    v_dot2c_f32_bf16 v113, s84, v134
    v_dot2c_f32_bf16 v114, s83, v135
    v_dot2c_f32_bf16 v115, s84, v135
    buffer_load_dwordx4 v[40:43], v2, s[32:35], s90 offen offset:256
    s_waitcnt vmcnt(14)
    v_dot2c_f32_bf16 v108, s83, v136
    v_dot2c_f32_bf16 v109, s84, v136
    v_dot2c_f32_bf16 v110, s83, v137
    v_dot2c_f32_bf16 v111, s84, v137
    v_dot2c_f32_bf16 v112, s83, v138
    v_dot2c_f32_bf16 v113, s84, v138
    v_dot2c_f32_bf16 v114, s83, v139
    v_dot2c_f32_bf16 v115, s84, v139
    buffer_load_dwordx4 v[44:47], v2, s[32:35], s90 offen offset:384
    s_waitcnt vmcnt(14)
    v_dot2c_f32_bf16 v108, s83, v140
    v_dot2c_f32_bf16 v109, s84, v140
    v_dot2c_f32_bf16 v110, s83, v141
    v_dot2c_f32_bf16 v111, s84, v141
    v_dot2c_f32_bf16 v112, s83, v142
    v_dot2c_f32_bf16 v113, s84, v142
    v_dot2c_f32_bf16 v114, s83, v143
    v_dot2c_f32_bf16 v115, s84, v143
    buffer_load_dwordx4 v[48:51], v2, s[32:35], s90 offen offset:512
    s_waitcnt vmcnt(14)
    v_dot2c_f32_bf16 v108, s83, v144
    v_dot2c_f32_bf16 v109, s84, v144
    v_dot2c_f32_bf16 v110, s83, v145
    v_dot2c_f32_bf16 v111, s84, v145
    v_dot2c_f32_bf16 v112, s83, v146
    v_dot2c_f32_bf16 v113, s84, v146
    v_dot2c_f32_bf16 v114, s83, v147
    v_dot2c_f32_bf16 v115, s84, v147
    buffer_load_dwordx4 v[52:55], v2, s[32:35], s90 offen offset:640
    s_waitcnt vmcnt(14)
    v_dot2c_f32_bf16 v108, s83, v148
    v_dot2c_f32_bf16 v109, s84, v148
    v_dot2c_f32_bf16 v110, s83, v149
    v_dot2c_f32_bf16 v111, s84, v149
    v_dot2c_f32_bf16 v112, s83, v150
    v_dot2c_f32_bf16 v113, s84, v150
    v_dot2c_f32_bf16 v114, s83, v151
    v_dot2c_f32_bf16 v115, s84, v151
    buffer_load_dwordx4 v[56:59], v2, s[32:35], s90 offen offset:768
    s_waitcnt vmcnt(14)
    v_dot2c_f32_bf16 v108, s83, v152
    v_dot2c_f32_bf16 v109, s84, v152
    v_dot2c_f32_bf16 v110, s83, v153
    v_dot2c_f32_bf16 v111, s84, v153
    v_dot2c_f32_bf16 v112, s83, v154
    v_dot2c_f32_bf16 v113, s84, v154
    v_dot2c_f32_bf16 v114, s83, v155
    v_dot2c_f32_bf16 v115, s84, v155
    buffer_load_dwordx4 v[60:63], v2, s[32:35], s91 offen offset:0
    s_waitcnt vmcnt(14)
    v_dot2c_f32_bf16 v108, s83, v156
    v_dot2c_f32_bf16 v109, s84, v156
    v_dot2c_f32_bf16 v110, s83, v157
    v_dot2c_f32_bf16 v111, s84, v157
    v_dot2c_f32_bf16 v112, s83, v158
    v_dot2c_f32_bf16 v113, s84, v158
    v_dot2c_f32_bf16 v114, s83, v159
    v_dot2c_f32_bf16 v115, s84, v159
    buffer_load_dwordx4 v[64:67], v2, s[32:35], s91 offen offset:128
    s_waitcnt vmcnt(14)
    v_dot2c_f32_bf16 v108, s83, v160
    v_dot2c_f32_bf16 v109, s84, v160
    v_dot2c_f32_bf16 v110, s83, v161
    v_dot2c_f32_bf16 v111, s84, v161
    v_dot2c_f32_bf16 v112, s83, v162
    v_dot2c_f32_bf16 v113, s84, v162
    v_dot2c_f32_bf16 v114, s83, v163
    v_dot2c_f32_bf16 v115, s84, v163
    buffer_load_dwordx4 v[68:71], v2, s[32:35], s91 offen offset:256
    s_waitcnt vmcnt(14)
    v_dot2c_f32_bf16 v108, s83, v164
    v_dot2c_f32_bf16 v109, s84, v164
    v_dot2c_f32_bf16 v110, s83, v165
    v_dot2c_f32_bf16 v111, s84, v165
    v_dot2c_f32_bf16 v112, s83, v166
    v_dot2c_f32_bf16 v113, s84, v166
    v_dot2c_f32_bf16 v114, s83, v167
    v_dot2c_f32_bf16 v115, s84, v167
    buffer_load_dwordx4 v[72:75], v2, s[32:35], s91 offen offset:384
    s_waitcnt vmcnt(14)
    v_dot2c_f32_bf16 v108, s83, v168
    v_dot2c_f32_bf16 v109, s84, v168
    v_dot2c_f32_bf16 v110, s83, v169
    v_dot2c_f32_bf16 v111, s84, v169
    v_dot2c_f32_bf16 v112, s83, v170
    v_dot2c_f32_bf16 v113, s84, v170
    v_dot2c_f32_bf16 v114, s83, v171
    v_dot2c_f32_bf16 v115, s84, v171
    buffer_load_dwordx4 v[76:79], v2, s[32:35], s91 offen offset:512
    s_waitcnt vmcnt(14)
    v_dot2c_f32_bf16 v108, s83, v172
    v_dot2c_f32_bf16 v109, s84, v172
    v_dot2c_f32_bf16 v110, s83, v173
    v_dot2c_f32_bf16 v111, s84, v173
    v_dot2c_f32_bf16 v112, s83, v174
    v_dot2c_f32_bf16 v113, s84, v174
    v_dot2c_f32_bf16 v114, s83, v175
    v_dot2c_f32_bf16 v115, s84, v175
    buffer_load_dwordx4 v[80:83], v2, s[32:35], s91 offen offset:640
    s_waitcnt vmcnt(14)
    v_dot2c_f32_bf16 v108, s83, v176
    v_dot2c_f32_bf16 v109, s84, v176
    v_dot2c_f32_bf16 v110, s83, v177
    v_dot2c_f32_bf16 v111, s84, v177
    v_dot2c_f32_bf16 v112, s83, v178
    v_dot2c_f32_bf16 v113, s84, v178
    v_dot2c_f32_bf16 v114, s83, v179
    v_dot2c_f32_bf16 v115, s84, v179
    buffer_load_dwordx4 v[84:87], v2, s[32:35], s91 offen offset:768
    s_waitcnt vmcnt(14)
    v_dot2c_f32_bf16 v108, s83, v180
    v_dot2c_f32_bf16 v109, s84, v180
    v_dot2c_f32_bf16 v110, s83, v181
    v_dot2c_f32_bf16 v111, s84, v181
    v_dot2c_f32_bf16 v112, s83, v182
    v_dot2c_f32_bf16 v113, s84, v182
    v_dot2c_f32_bf16 v114, s83, v183
    v_dot2c_f32_bf16 v115, s84, v183
    v_readfirstlane_b32 s78, v7
    s_nop 3
    s_mul_i32 s78, s78, 1664525
    s_add_u32 s78, s78, 1013904223
    v_accvgpr_write_b32 a224, s78
    s_nop 2
    ds_write_b128 v10, v[108:111] offset:0
    ds_write_b128 v10, v[112:115] offset:16
    s_waitcnt lgkmcnt(0)
    s_barrier
    ds_read2st64_b32 v[128:129], v11 offset0:0 offset1:1
    ds_read2st64_b32 v[130:131], v11 offset0:2 offset1:3
    ds_read2st64_b32 v[132:133], v11 offset0:4 offset1:5
    ds_read2st64_b32 v[134:135], v11 offset0:6 offset1:7
    ds_read2st64_b32 v[136:137], v11 offset0:8 offset1:9
    ds_read2st64_b32 v[138:139], v11 offset0:10 offset1:11
    ds_read2st64_b32 v[140:141], v11 offset0:12 offset1:13
    ds_read2st64_b32 v[142:143], v11 offset0:14 offset1:15
    ds_read2st64_b32 v[144:145], v11 offset0:16 offset1:17
    ds_read2st64_b32 v[146:147], v11 offset0:18 offset1:19
    ds_read2st64_b32 v[148:149], v11 offset0:20 offset1:21
    ds_read2st64_b32 v[150:151], v11 offset0:22 offset1:23
    ds_read2st64_b32 v[152:153], v11 offset0:24 offset1:25
    ds_read2st64_b32 v[154:155], v11 offset0:26 offset1:27
    ds_read2st64_b32 v[156:157], v11 offset0:28 offset1:29
    ds_read2st64_b32 v[158:159], v11 offset0:30 offset1:31
    s_waitcnt lgkmcnt(0)
    v_add_f32 v128, v128, v129
    v_add_f32 v130, v130, v131
    v_add_f32 v132, v132, v133
    v_add_f32 v134, v134, v135
    v_add_f32 v136, v136, v137
    v_add_f32 v138, v138, v139
    v_add_f32 v140, v140, v141
    v_add_f32 v142, v142, v143
    v_add_f32 v144, v144, v145
    v_add_f32 v146, v146, v147
    v_add_f32 v148, v148, v149
    v_add_f32 v150, v150, v151
    v_add_f32 v152, v152, v153
    v_add_f32 v154, v154, v155
    v_add_f32 v156, v156, v157
    v_add_f32 v158, v158, v159
    v_add_f32 v128, v128, v130
    v_add_f32 v132, v132, v134
    v_add_f32 v136, v136, v138
    v_add_f32 v140, v140, v142
    v_add_f32 v144, v144, v146
    v_add_f32 v148, v148, v150
    v_add_f32 v152, v152, v154
    v_add_f32 v156, v156, v158
    v_add_f32 v128, v128, v132
    v_add_f32 v136, v136, v140
    v_add_f32 v144, v144, v148
    v_add_f32 v152, v152, v156
    v_add_f32 v128, v128, v136
    v_add_f32 v144, v144, v152
    v_add_f32 v128, v128, v144
    v_cvt_pk_bf16_f32 v116, v128, v128
    v_lshlrev_b32 v117, 16, v116
    v_sub_f32 v128, v128, v117
    v_cvt_pk_bf16_f32 v118, v128, v128
    v_lshlrev_b32 v117, 16, v118
    v_sub_f32 v128, v128, v117
    v_and_b32 v116, 0xffff, v116
    v_or_b32 v116, v116, v117
    v_cvt_pk_bf16_f32 v117, v128, v128
    v_and_b32 v117, 0xffff, v117
    v_mov_b32 v118, 0
    v_mov_b32 v119, s78
    buffer_store_dwordx4 v[116:119], v12, s[68:71], s87 offen offset:0 sc1
    v_and_b32 v2, 7, v1
    v_cmp_eq_u32 vcc, 0, v2
    v_mov_b32 v3, 0x80000000
    v_lshlrev_b32 v5, 1, v1
    v_cndmask_b32 v100, v3, v1, vcc
    v_cndmask_b32 v101, v3, v5, vcc
    s_lshl_b32 s90, s75, 2
    s_add_u32 s90, s90, s72
    s_lshl_b32 s90, s90, 7
    s_add_u32 s85, s90, 12845056
    s_lshl_b32 s90, s90, 1
    s_add_u32 s95, s90, 12926976
    v_mov_b32 v88, 0
    v_mov_b32 v89, 0
    s_waitcnt vmcnt(8)
    v_dot2c_f32_bf16 v88, s82, v32
    v_dot2c_f32_bf16 v89, s82, v33
    v_dot2c_f32_bf16 v88, s82, v34
    v_dot2c_f32_bf16 v89, s82, v35
    v_dot2c_f32_bf16 v88, s82, v36
    v_dot2c_f32_bf16 v89, s82, v37
    v_dot2c_f32_bf16 v88, s82, v38
    v_dot2c_f32_bf16 v89, s82, v39
    v_dot2c_f32_bf16 v88, s82, v40
    v_dot2c_f32_bf16 v89, s82, v41
    v_dot2c_f32_bf16 v88, s82, v42
    v_dot2c_f32_bf16 v89, s82, v43
    v_dot2c_f32_bf16 v88, s82, v44
    v_dot2c_f32_bf16 v89, s82, v45
    v_dot2c_f32_bf16 v88, s82, v46
    v_dot2c_f32_bf16 v89, s82, v47
    v_dot2c_f32_bf16 v88, s82, v48
    v_dot2c_f32_bf16 v89, s82, v49
    v_dot2c_f32_bf16 v88, s82, v50
    v_dot2c_f32_bf16 v89, s82, v51
    v_dot2c_f32_bf16 v88, s82, v52
    v_dot2c_f32_bf16 v89, s82, v53
    v_dot2c_f32_bf16 v88, s82, v54
    v_dot2c_f32_bf16 v89, s82, v55
    v_dot2c_f32_bf16 v88, s82, v56
    v_dot2c_f32_bf16 v89, s82, v57
    v_dot2c_f32_bf16 v88, s82, v58
    v_dot2c_f32_bf16 v89, s82, v59
    s_nop 2
    v_add_f32 v90, v88, v89
    s_nop 1
    v_add_f32_dpp v90, v90, v90 quad_perm:[1,0,3,2] row_mask:0xf bank_mask:0xf
    s_nop 1
    v_add_f32_dpp v90, v90, v90 quad_perm:[2,3,0,1] row_mask:0xf bank_mask:0xf
    s_nop 1
    v_add_f32_dpp v90, v90, v90 row_half_mirror row_mask:0xf bank_mask:0xf
    v_mul_f32 v90, 0x3b124925, v90
    v_cvt_pk_bf16_f32 v92, v90, v90
    v_lshlrev_b32 v92, 16, v92
    v_mov_b32 v93, s78
    buffer_store_dwordx2 v[92:93], v100, s[68:71], s85 offen offset:0 sc1
    v_mov_b32 v88, 0
    v_mov_b32 v89, 0
    s_waitcnt vmcnt(2)
    v_dot2c_f32_bf16 v88, s82, v60
    v_dot2c_f32_bf16 v89, s82, v61
    v_dot2c_f32_bf16 v88, s82, v62
    v_dot2c_f32_bf16 v89, s82, v63
    v_dot2c_f32_bf16 v88, s82, v64
    v_dot2c_f32_bf16 v89, s82, v65
    v_dot2c_f32_bf16 v88, s82, v66
    v_dot2c_f32_bf16 v89, s82, v67
    v_dot2c_f32_bf16 v88, s82, v68
    v_dot2c_f32_bf16 v89, s82, v69
    v_dot2c_f32_bf16 v88, s82, v70
    v_dot2c_f32_bf16 v89, s82, v71
    v_dot2c_f32_bf16 v88, s82, v72
    v_dot2c_f32_bf16 v89, s82, v73
    v_dot2c_f32_bf16 v88, s82, v74
    v_dot2c_f32_bf16 v89, s82, v75
    v_dot2c_f32_bf16 v88, s82, v76
    v_dot2c_f32_bf16 v89, s82, v77
    v_dot2c_f32_bf16 v88, s82, v78
    v_dot2c_f32_bf16 v89, s82, v79
    v_dot2c_f32_bf16 v88, s82, v80
    v_dot2c_f32_bf16 v89, s82, v81
    v_dot2c_f32_bf16 v88, s82, v82
    v_dot2c_f32_bf16 v89, s82, v83
    v_dot2c_f32_bf16 v88, s82, v84
    v_dot2c_f32_bf16 v89, s82, v85
    v_dot2c_f32_bf16 v88, s82, v86
    v_dot2c_f32_bf16 v89, s82, v87
    s_nop 2
    v_add_f32 v91, v88, v89
    s_nop 1
    v_add_f32_dpp v91, v91, v91 quad_perm:[1,0,3,2] row_mask:0xf bank_mask:0xf
    s_nop 1
    v_add_f32_dpp v91, v91, v91 quad_perm:[2,3,0,1] row_mask:0xf bank_mask:0xf
    s_nop 1
    v_add_f32_dpp v91, v91, v91 row_half_mirror row_mask:0xf bank_mask:0xf
    v_mul_f32 v91, 0x3b124925, v91
    v_cvt_pk_bf16_f32 v96, v91, v91
    v_lshlrev_b32 v96, 16, v96
    v_mov_b32 v97, s78
    buffer_store_dwordx2 v[96:97], v100, s[68:71], s85 offen offset:64 sc1
    s_add_u32 s96, s93, 128
    buffer_load_dwordx4 v[184:187], v4, s[56:59], s96 offen
    s_add_u32 s96, s93, 114816
    buffer_load_dwordx4 v[188:191], v4, s[56:59], s96 offen
    s_add_u32 s96, s93, 229504
    buffer_load_dwordx4 v[192:195], v4, s[56:59], s96 offen
    s_add_u32 s96, s93, 344192
    buffer_load_dwordx4 v[196:199], v4, s[56:59], s96 offen
    s_add_u32 s96, s93, 458880
    buffer_load_dwordx4 v[200:203], v4, s[56:59], s96 offen
    s_add_u32 s96, s93, 573568
    buffer_load_dwordx4 v[204:207], v4, s[56:59], s96 offen
    s_add_u32 s96, s93, 688256
    buffer_load_dwordx4 v[208:211], v4, s[56:59], s96 offen
    s_add_u32 s96, s93, 802944
    buffer_load_dwordx4 v[212:215], v4, s[56:59], s96 offen
    s_add_u32 s96, s93, 917632
    buffer_load_dwordx4 v[216:219], v4, s[56:59], s96 offen
    s_add_u32 s96, s93, 1032320
    buffer_load_dwordx4 v[220:223], v4, s[56:59], s96 offen
    s_add_u32 s96, s93, 1147008
    buffer_load_dwordx4 v[224:227], v4, s[56:59], s96 offen
    s_add_u32 s96, s93, 1261696
    buffer_load_dwordx4 v[228:231], v4, s[56:59], s96 offen
    s_add_u32 s96, s93, 1376384
    buffer_load_dwordx4 v[232:235], v4, s[56:59], s96 offen
    s_add_u32 s96, s93, 1491072
    buffer_load_dwordx4 v[236:239], v4, s[56:59], s96 offen
    v_mov_b32 v108, 0
    v_mov_b32 v109, 0
    v_mov_b32 v110, 0
    v_mov_b32 v111, 0
    v_mov_b32 v112, 0
    v_mov_b32 v113, 0
    v_mov_b32 v114, 0
    v_mov_b32 v115, 0
    s_waitcnt vmcnt(13)
    v_dot2c_f32_bf16 v108, s83, v184
    v_dot2c_f32_bf16 v109, s84, v184
    v_dot2c_f32_bf16 v110, s83, v185
    v_dot2c_f32_bf16 v111, s84, v185
    v_dot2c_f32_bf16 v112, s83, v186
    v_dot2c_f32_bf16 v113, s84, v186
    v_dot2c_f32_bf16 v114, s83, v187
    v_dot2c_f32_bf16 v115, s84, v187
    s_waitcnt vmcnt(12)
    v_dot2c_f32_bf16 v108, s83, v188
    v_dot2c_f32_bf16 v109, s84, v188
    v_dot2c_f32_bf16 v110, s83, v189
    v_dot2c_f32_bf16 v111, s84, v189
    v_dot2c_f32_bf16 v112, s83, v190
    v_dot2c_f32_bf16 v113, s84, v190
    v_dot2c_f32_bf16 v114, s83, v191
    v_dot2c_f32_bf16 v115, s84, v191
    s_waitcnt vmcnt(11)
    v_dot2c_f32_bf16 v108, s83, v192
    v_dot2c_f32_bf16 v109, s84, v192
    v_dot2c_f32_bf16 v110, s83, v193
    v_dot2c_f32_bf16 v111, s84, v193
    v_dot2c_f32_bf16 v112, s83, v194
    v_dot2c_f32_bf16 v113, s84, v194
    v_dot2c_f32_bf16 v114, s83, v195
    v_dot2c_f32_bf16 v115, s84, v195
    s_waitcnt vmcnt(10)
    v_dot2c_f32_bf16 v108, s83, v196
    v_dot2c_f32_bf16 v109, s84, v196
    v_dot2c_f32_bf16 v110, s83, v197
    v_dot2c_f32_bf16 v111, s84, v197
    v_dot2c_f32_bf16 v112, s83, v198
    v_dot2c_f32_bf16 v113, s84, v198
    v_dot2c_f32_bf16 v114, s83, v199
    v_dot2c_f32_bf16 v115, s84, v199
    s_waitcnt vmcnt(9)
    v_dot2c_f32_bf16 v108, s83, v200
    v_dot2c_f32_bf16 v109, s84, v200
    v_dot2c_f32_bf16 v110, s83, v201
    v_dot2c_f32_bf16 v111, s84, v201
    v_dot2c_f32_bf16 v112, s83, v202
    v_dot2c_f32_bf16 v113, s84, v202
    v_dot2c_f32_bf16 v114, s83, v203
    v_dot2c_f32_bf16 v115, s84, v203
    s_waitcnt vmcnt(8)
    v_dot2c_f32_bf16 v108, s83, v204
    v_dot2c_f32_bf16 v109, s84, v204
    v_dot2c_f32_bf16 v110, s83, v205
    v_dot2c_f32_bf16 v111, s84, v205
    v_dot2c_f32_bf16 v112, s83, v206
    v_dot2c_f32_bf16 v113, s84, v206
    v_dot2c_f32_bf16 v114, s83, v207
    v_dot2c_f32_bf16 v115, s84, v207
    s_waitcnt vmcnt(7)
    v_dot2c_f32_bf16 v108, s83, v208
    v_dot2c_f32_bf16 v109, s84, v208
    v_dot2c_f32_bf16 v110, s83, v209
    v_dot2c_f32_bf16 v111, s84, v209
    v_dot2c_f32_bf16 v112, s83, v210
    v_dot2c_f32_bf16 v113, s84, v210
    v_dot2c_f32_bf16 v114, s83, v211
    v_dot2c_f32_bf16 v115, s84, v211
    s_waitcnt vmcnt(6)
    v_dot2c_f32_bf16 v108, s83, v212
    v_dot2c_f32_bf16 v109, s84, v212
    v_dot2c_f32_bf16 v110, s83, v213
    v_dot2c_f32_bf16 v111, s84, v213
    v_dot2c_f32_bf16 v112, s83, v214
    v_dot2c_f32_bf16 v113, s84, v214
    v_dot2c_f32_bf16 v114, s83, v215
    v_dot2c_f32_bf16 v115, s84, v215
    s_waitcnt vmcnt(5)
    v_dot2c_f32_bf16 v108, s83, v216
    v_dot2c_f32_bf16 v109, s84, v216
    v_dot2c_f32_bf16 v110, s83, v217
    v_dot2c_f32_bf16 v111, s84, v217
    v_dot2c_f32_bf16 v112, s83, v218
    v_dot2c_f32_bf16 v113, s84, v218
    v_dot2c_f32_bf16 v114, s83, v219
    v_dot2c_f32_bf16 v115, s84, v219
    s_waitcnt vmcnt(4)
    v_dot2c_f32_bf16 v108, s83, v220
    v_dot2c_f32_bf16 v109, s84, v220
    v_dot2c_f32_bf16 v110, s83, v221
    v_dot2c_f32_bf16 v111, s84, v221
    v_dot2c_f32_bf16 v112, s83, v222
    v_dot2c_f32_bf16 v113, s84, v222
    v_dot2c_f32_bf16 v114, s83, v223
    v_dot2c_f32_bf16 v115, s84, v223
    s_waitcnt vmcnt(3)
    v_dot2c_f32_bf16 v108, s83, v224
    v_dot2c_f32_bf16 v109, s84, v224
    v_dot2c_f32_bf16 v110, s83, v225
    v_dot2c_f32_bf16 v111, s84, v225
    v_dot2c_f32_bf16 v112, s83, v226
    v_dot2c_f32_bf16 v113, s84, v226
    v_dot2c_f32_bf16 v114, s83, v227
    v_dot2c_f32_bf16 v115, s84, v227
    s_waitcnt vmcnt(2)
    v_dot2c_f32_bf16 v108, s83, v228
    v_dot2c_f32_bf16 v109, s84, v228
    v_dot2c_f32_bf16 v110, s83, v229
    v_dot2c_f32_bf16 v111, s84, v229
    v_dot2c_f32_bf16 v112, s83, v230
    v_dot2c_f32_bf16 v113, s84, v230
    v_dot2c_f32_bf16 v114, s83, v231
    v_dot2c_f32_bf16 v115, s84, v231
    s_waitcnt vmcnt(1)
    v_dot2c_f32_bf16 v108, s83, v232
    v_dot2c_f32_bf16 v109, s84, v232
    v_dot2c_f32_bf16 v110, s83, v233
    v_dot2c_f32_bf16 v111, s84, v233
    v_dot2c_f32_bf16 v112, s83, v234
    v_dot2c_f32_bf16 v113, s84, v234
    v_dot2c_f32_bf16 v114, s83, v235
    v_dot2c_f32_bf16 v115, s84, v235
    s_waitcnt vmcnt(0)
    v_dot2c_f32_bf16 v108, s83, v236
    v_dot2c_f32_bf16 v109, s84, v236
    v_dot2c_f32_bf16 v110, s83, v237
    v_dot2c_f32_bf16 v111, s84, v237
    v_dot2c_f32_bf16 v112, s83, v238
    v_dot2c_f32_bf16 v113, s84, v238
    v_dot2c_f32_bf16 v114, s83, v239
    v_dot2c_f32_bf16 v115, s84, v239
    s_nop 2
    ds_write_b128 v10, v[108:111] offset:8192
    ds_write_b128 v10, v[112:115] offset:8208
    s_waitcnt lgkmcnt(0)
    s_barrier
    ds_read2st64_b32 v[128:129], v11 offset0:32 offset1:33
    ds_read2st64_b32 v[130:131], v11 offset0:34 offset1:35
    ds_read2st64_b32 v[132:133], v11 offset0:36 offset1:37
    ds_read2st64_b32 v[134:135], v11 offset0:38 offset1:39
    ds_read2st64_b32 v[136:137], v11 offset0:40 offset1:41
    ds_read2st64_b32 v[138:139], v11 offset0:42 offset1:43
    ds_read2st64_b32 v[140:141], v11 offset0:44 offset1:45
    ds_read2st64_b32 v[142:143], v11 offset0:46 offset1:47
    ds_read2st64_b32 v[144:145], v11 offset0:48 offset1:49
    ds_read2st64_b32 v[146:147], v11 offset0:50 offset1:51
    ds_read2st64_b32 v[148:149], v11 offset0:52 offset1:53
    ds_read2st64_b32 v[150:151], v11 offset0:54 offset1:55
    ds_read2st64_b32 v[152:153], v11 offset0:56 offset1:57
    ds_read2st64_b32 v[154:155], v11 offset0:58 offset1:59
    ds_read2st64_b32 v[156:157], v11 offset0:60 offset1:61
    ds_read2st64_b32 v[158:159], v11 offset0:62 offset1:63
    s_waitcnt lgkmcnt(0)
    v_add_f32 v128, v128, v129
    v_add_f32 v130, v130, v131
    v_add_f32 v132, v132, v133
    v_add_f32 v134, v134, v135
    v_add_f32 v136, v136, v137
    v_add_f32 v138, v138, v139
    v_add_f32 v140, v140, v141
    v_add_f32 v142, v142, v143
    v_add_f32 v144, v144, v145
    v_add_f32 v146, v146, v147
    v_add_f32 v148, v148, v149
    v_add_f32 v150, v150, v151
    v_add_f32 v152, v152, v153
    v_add_f32 v154, v154, v155
    v_add_f32 v156, v156, v157
    v_add_f32 v158, v158, v159
    v_add_f32 v128, v128, v130
    v_add_f32 v132, v132, v134
    v_add_f32 v136, v136, v138
    v_add_f32 v140, v140, v142
    v_add_f32 v144, v144, v146
    v_add_f32 v148, v148, v150
    v_add_f32 v152, v152, v154
    v_add_f32 v156, v156, v158
    v_add_f32 v128, v128, v132
    v_add_f32 v136, v136, v140
    v_add_f32 v144, v144, v148
    v_add_f32 v152, v152, v156
    v_add_f32 v128, v128, v136
    v_add_f32 v144, v144, v152
    v_add_f32 v128, v128, v144
    v_cvt_pk_bf16_f32 v116, v128, v128
    v_lshlrev_b32 v117, 16, v116
    v_sub_f32 v128, v128, v117
    v_cvt_pk_bf16_f32 v118, v128, v128
    v_lshlrev_b32 v117, 16, v118
    v_sub_f32 v128, v128, v117
    v_and_b32 v116, 0xffff, v116
    v_or_b32 v116, v116, v117
    v_cvt_pk_bf16_f32 v117, v128, v128
    v_and_b32 v117, 0xffff, v117
    v_mov_b32 v118, 0
    v_mov_b32 v119, s78
    buffer_store_dwordx4 v[116:119], v12, s[68:71], s87 offen offset:2048 sc1
    s_and_b32 s90, s2, 1
    s_mul_i32 s90, s90, 6272
    s_lshr_b32 s91, s2, 3
    s_lshl_b32 s91, s91, 2
    s_add_u32 s91, s91, s72
    s_mul_i32 s91, s91, 392
    s_add_u32 s90, s90, s91
    s_lshl_b32 s77, s90, 7
    v_min_u32 v14, 55, v1
    v_lshlrev_b32 v14, 7, v14
    s_bfe_u32 s76, s2, 0x20001
    s_mul_i32 s76, s76, 14336
    s_add_u32 s91, s77, s76
    s_add_u32 s76, s76, 7168
    s_cmp_eq_u32 s76, 50176
    s_cselect_b32 s76, 0, s76
    buffer_load_dword v240, v14, s[60:63], s91 offen
    s_add_u32 s91, s77, s76
    s_add_u32 s76, s76, 7168
    s_cmp_eq_u32 s76, 50176
    s_cselect_b32 s76, 0, s76
    buffer_load_dword v241, v14, s[60:63], s91 offen
    s_add_u32 s91, s77, s76
    s_add_u32 s76, s76, 7168
    s_cmp_eq_u32 s76, 50176
    s_cselect_b32 s76, 0, s76
    buffer_load_dword v242, v14, s[60:63], s91 offen
    s_add_u32 s91, s77, s76
    s_add_u32 s76, s76, 7168
    s_cmp_eq_u32 s76, 50176
    s_cselect_b32 s76, 0, s76
    buffer_load_dword v243, v14, s[60:63], s91 offen
    v_mov_b32 v102, 0
    v_mov_b32 v103, 0
    v_lshlrev_b32 v88, 16, v32
    v_and_b32 v89, 0xffff0000, v32
    v_sub_f32 v88, v88, v90
    v_sub_f32 v89, v89, v90
    v_fmac_f32 v102, v88, v88
    v_fmac_f32 v103, v89, v89
    v_lshlrev_b32 v88, 16, v33
    v_and_b32 v89, 0xffff0000, v33
    v_sub_f32 v88, v88, v90
    v_sub_f32 v89, v89, v90
    v_fmac_f32 v102, v88, v88
    v_fmac_f32 v103, v89, v89
    v_lshlrev_b32 v88, 16, v34
    v_and_b32 v89, 0xffff0000, v34
    v_sub_f32 v88, v88, v90
    v_sub_f32 v89, v89, v90
    v_fmac_f32 v102, v88, v88
    v_fmac_f32 v103, v89, v89
    v_lshlrev_b32 v88, 16, v35
    v_and_b32 v89, 0xffff0000, v35
    v_sub_f32 v88, v88, v90
    v_sub_f32 v89, v89, v90
    v_fmac_f32 v102, v88, v88
    v_fmac_f32 v103, v89, v89
    v_lshlrev_b32 v88, 16, v36
    v_and_b32 v89, 0xffff0000, v36
    v_sub_f32 v88, v88, v90
    v_sub_f32 v89, v89, v90
    v_fmac_f32 v102, v88, v88
    v_fmac_f32 v103, v89, v89
    v_lshlrev_b32 v88, 16, v37
    v_and_b32 v89, 0xffff0000, v37
    v_sub_f32 v88, v88, v90
    v_sub_f32 v89, v89, v90
    v_fmac_f32 v102, v88, v88
    v_fmac_f32 v103, v89, v89
    v_lshlrev_b32 v88, 16, v38
    v_and_b32 v89, 0xffff0000, v38
    v_sub_f32 v88, v88, v90
    v_sub_f32 v89, v89, v90
    v_fmac_f32 v102, v88, v88
    v_fmac_f32 v103, v89, v89
    v_lshlrev_b32 v88, 16, v39
    v_and_b32 v89, 0xffff0000, v39
    v_sub_f32 v88, v88, v90
    v_sub_f32 v89, v89, v90
    v_fmac_f32 v102, v88, v88
    v_fmac_f32 v103, v89, v89
    v_lshlrev_b32 v88, 16, v40
    v_and_b32 v89, 0xffff0000, v40
    v_sub_f32 v88, v88, v90
    v_sub_f32 v89, v89, v90
    v_fmac_f32 v102, v88, v88
    v_fmac_f32 v103, v89, v89
    v_lshlrev_b32 v88, 16, v41
    v_and_b32 v89, 0xffff0000, v41
    v_sub_f32 v88, v88, v90
    v_sub_f32 v89, v89, v90
    v_fmac_f32 v102, v88, v88
    v_fmac_f32 v103, v89, v89
    v_lshlrev_b32 v88, 16, v42
    v_and_b32 v89, 0xffff0000, v42
    v_sub_f32 v88, v88, v90
    v_sub_f32 v89, v89, v90
    v_fmac_f32 v102, v88, v88
    v_fmac_f32 v103, v89, v89
    v_lshlrev_b32 v88, 16, v43
    v_and_b32 v89, 0xffff0000, v43
    v_sub_f32 v88, v88, v90
    v_sub_f32 v89, v89, v90
    v_fmac_f32 v102, v88, v88
    v_fmac_f32 v103, v89, v89
    v_lshlrev_b32 v88, 16, v44
    v_and_b32 v89, 0xffff0000, v44
    v_sub_f32 v88, v88, v90
    v_sub_f32 v89, v89, v90
    v_fmac_f32 v102, v88, v88
    v_fmac_f32 v103, v89, v89
    v_lshlrev_b32 v88, 16, v45
    v_and_b32 v89, 0xffff0000, v45
    v_sub_f32 v88, v88, v90
    v_sub_f32 v89, v89, v90
    v_fmac_f32 v102, v88, v88
    v_fmac_f32 v103, v89, v89
    s_add_u32 s91, s77, s76
    s_add_u32 s76, s76, 7168
    s_cmp_eq_u32 s76, 50176
    s_cselect_b32 s76, 0, s76
    buffer_load_dword v244, v14, s[60:63], s91 offen
    v_lshlrev_b32 v88, 16, v46
    v_and_b32 v89, 0xffff0000, v46
    v_sub_f32 v88, v88, v90
    v_sub_f32 v89, v89, v90
    v_fmac_f32 v102, v88, v88
    v_fmac_f32 v103, v89, v89
    v_lshlrev_b32 v88, 16, v47
    v_and_b32 v89, 0xffff0000, v47
    v_sub_f32 v88, v88, v90
    v_sub_f32 v89, v89, v90
    v_fmac_f32 v102, v88, v88
    v_fmac_f32 v103, v89, v89
    v_lshlrev_b32 v88, 16, v48
    v_and_b32 v89, 0xffff0000, v48
    v_sub_f32 v88, v88, v90
    v_sub_f32 v89, v89, v90
    v_fmac_f32 v102, v88, v88
    v_fmac_f32 v103, v89, v89
    v_lshlrev_b32 v88, 16, v49
    v_and_b32 v89, 0xffff0000, v49
    v_sub_f32 v88, v88, v90
    v_sub_f32 v89, v89, v90
    v_fmac_f32 v102, v88, v88
    v_fmac_f32 v103, v89, v89
    v_lshlrev_b32 v88, 16, v50
    v_and_b32 v89, 0xffff0000, v50
    v_sub_f32 v88, v88, v90
    v_sub_f32 v89, v89, v90
    v_fmac_f32 v102, v88, v88
    v_fmac_f32 v103, v89, v89
    v_lshlrev_b32 v88, 16, v51
    v_and_b32 v89, 0xffff0000, v51
    v_sub_f32 v88, v88, v90
    v_sub_f32 v89, v89, v90
    v_fmac_f32 v102, v88, v88
    v_fmac_f32 v103, v89, v89
    v_lshlrev_b32 v88, 16, v52
    v_and_b32 v89, 0xffff0000, v52
    v_sub_f32 v88, v88, v90
    v_sub_f32 v89, v89, v90
    v_fmac_f32 v102, v88, v88
    v_fmac_f32 v103, v89, v89
    v_lshlrev_b32 v88, 16, v53
    v_and_b32 v89, 0xffff0000, v53
    v_sub_f32 v88, v88, v90
    v_sub_f32 v89, v89, v90
    v_fmac_f32 v102, v88, v88
    v_fmac_f32 v103, v89, v89
    v_lshlrev_b32 v88, 16, v54
    v_and_b32 v89, 0xffff0000, v54
    v_sub_f32 v88, v88, v90
    v_sub_f32 v89, v89, v90
    v_fmac_f32 v102, v88, v88
    v_fmac_f32 v103, v89, v89
    v_lshlrev_b32 v88, 16, v55
    v_and_b32 v89, 0xffff0000, v55
    v_sub_f32 v88, v88, v90
    v_sub_f32 v89, v89, v90
    v_fmac_f32 v102, v88, v88
    v_fmac_f32 v103, v89, v89
    v_lshlrev_b32 v88, 16, v56
    v_and_b32 v89, 0xffff0000, v56
    v_sub_f32 v88, v88, v90
    v_sub_f32 v89, v89, v90
    v_fmac_f32 v102, v88, v88
    v_fmac_f32 v103, v89, v89
    v_lshlrev_b32 v88, 16, v57
    v_and_b32 v89, 0xffff0000, v57
    v_sub_f32 v88, v88, v90
    v_sub_f32 v89, v89, v90
    v_fmac_f32 v102, v88, v88
    v_fmac_f32 v103, v89, v89
    v_lshlrev_b32 v88, 16, v58
    v_and_b32 v89, 0xffff0000, v58
    v_sub_f32 v88, v88, v90
    v_sub_f32 v89, v89, v90
    v_fmac_f32 v102, v88, v88
    v_fmac_f32 v103, v89, v89
    v_lshlrev_b32 v88, 16, v59
    v_and_b32 v89, 0xffff0000, v59
    v_sub_f32 v88, v88, v90
    v_sub_f32 v89, v89, v90
    v_fmac_f32 v102, v88, v88
    v_fmac_f32 v103, v89, v89
    v_mov_b32 v104, 0
    v_mov_b32 v105, 0
    s_add_u32 s91, s77, s76
    s_add_u32 s76, s76, 7168
    s_cmp_eq_u32 s76, 50176
    s_cselect_b32 s76, 0, s76
    buffer_load_dword v245, v14, s[60:63], s91 offen
    v_lshlrev_b32 v88, 16, v60
    v_and_b32 v89, 0xffff0000, v60
    v_sub_f32 v88, v88, v91
    v_sub_f32 v89, v89, v91
    v_fmac_f32 v104, v88, v88
    v_fmac_f32 v105, v89, v89
    v_lshlrev_b32 v88, 16, v61
    v_and_b32 v89, 0xffff0000, v61
    v_sub_f32 v88, v88, v91
    v_sub_f32 v89, v89, v91
    v_fmac_f32 v104, v88, v88
    v_fmac_f32 v105, v89, v89
    v_lshlrev_b32 v88, 16, v62
    v_and_b32 v89, 0xffff0000, v62
    v_sub_f32 v88, v88, v91
    v_sub_f32 v89, v89, v91
    v_fmac_f32 v104, v88, v88
    v_fmac_f32 v105, v89, v89
    v_lshlrev_b32 v88, 16, v63
    v_and_b32 v89, 0xffff0000, v63
    v_sub_f32 v88, v88, v91
    v_sub_f32 v89, v89, v91
    v_fmac_f32 v104, v88, v88
    v_fmac_f32 v105, v89, v89
    v_lshlrev_b32 v88, 16, v64
    v_and_b32 v89, 0xffff0000, v64
    v_sub_f32 v88, v88, v91
    v_sub_f32 v89, v89, v91
    v_fmac_f32 v104, v88, v88
    v_fmac_f32 v105, v89, v89
    v_lshlrev_b32 v88, 16, v65
    v_and_b32 v89, 0xffff0000, v65
    v_sub_f32 v88, v88, v91
    v_sub_f32 v89, v89, v91
    v_fmac_f32 v104, v88, v88
    v_fmac_f32 v105, v89, v89
    v_lshlrev_b32 v88, 16, v66
    v_and_b32 v89, 0xffff0000, v66
    v_sub_f32 v88, v88, v91
    v_sub_f32 v89, v89, v91
    v_fmac_f32 v104, v88, v88
    v_fmac_f32 v105, v89, v89
    v_lshlrev_b32 v88, 16, v67
    v_and_b32 v89, 0xffff0000, v67
    v_sub_f32 v88, v88, v91
    v_sub_f32 v89, v89, v91
    v_fmac_f32 v104, v88, v88
    v_fmac_f32 v105, v89, v89
    v_lshlrev_b32 v88, 16, v68
    v_and_b32 v89, 0xffff0000, v68
    v_sub_f32 v88, v88, v91
    v_sub_f32 v89, v89, v91
    v_fmac_f32 v104, v88, v88
    v_fmac_f32 v105, v89, v89
    v_lshlrev_b32 v88, 16, v69
    v_and_b32 v89, 0xffff0000, v69
    v_sub_f32 v88, v88, v91
    v_sub_f32 v89, v89, v91
    v_fmac_f32 v104, v88, v88
    v_fmac_f32 v105, v89, v89
    v_lshlrev_b32 v88, 16, v70
    v_and_b32 v89, 0xffff0000, v70
    v_sub_f32 v88, v88, v91
    v_sub_f32 v89, v89, v91
    v_fmac_f32 v104, v88, v88
    v_fmac_f32 v105, v89, v89
    v_lshlrev_b32 v88, 16, v71
    v_and_b32 v89, 0xffff0000, v71
    v_sub_f32 v88, v88, v91
    v_sub_f32 v89, v89, v91
    v_fmac_f32 v104, v88, v88
    v_fmac_f32 v105, v89, v89
    v_lshlrev_b32 v88, 16, v72
    v_and_b32 v89, 0xffff0000, v72
    v_sub_f32 v88, v88, v91
    v_sub_f32 v89, v89, v91
    v_fmac_f32 v104, v88, v88
    v_fmac_f32 v105, v89, v89
    v_lshlrev_b32 v88, 16, v73
    v_and_b32 v89, 0xffff0000, v73
    v_sub_f32 v88, v88, v91
    v_sub_f32 v89, v89, v91
    v_fmac_f32 v104, v88, v88
    v_fmac_f32 v105, v89, v89
    v_lshlrev_b32 v88, 16, v74
    v_and_b32 v89, 0xffff0000, v74
    v_sub_f32 v88, v88, v91
    v_sub_f32 v89, v89, v91
    v_fmac_f32 v104, v88, v88
    v_fmac_f32 v105, v89, v89
    s_add_u32 s91, s77, s76
    s_add_u32 s76, s76, 7168
    s_cmp_eq_u32 s76, 50176
    s_cselect_b32 s76, 0, s76
    buffer_load_dword v246, v14, s[60:63], s91 offen
    v_lshlrev_b32 v88, 16, v75
    v_and_b32 v89, 0xffff0000, v75
    v_sub_f32 v88, v88, v91
    v_sub_f32 v89, v89, v91
    v_fmac_f32 v104, v88, v88
    v_fmac_f32 v105, v89, v89
    v_lshlrev_b32 v88, 16, v76
    v_and_b32 v89, 0xffff0000, v76
    v_sub_f32 v88, v88, v91
    v_sub_f32 v89, v89, v91
    v_fmac_f32 v104, v88, v88
    v_fmac_f32 v105, v89, v89
    v_lshlrev_b32 v88, 16, v77
    v_and_b32 v89, 0xffff0000, v77
    v_sub_f32 v88, v88, v91
    v_sub_f32 v89, v89, v91
    v_fmac_f32 v104, v88, v88
    v_fmac_f32 v105, v89, v89
    v_lshlrev_b32 v88, 16, v78
    v_and_b32 v89, 0xffff0000, v78
    v_sub_f32 v88, v88, v91
    v_sub_f32 v89, v89, v91
    v_fmac_f32 v104, v88, v88
    v_fmac_f32 v105, v89, v89
    v_lshlrev_b32 v88, 16, v79
    v_and_b32 v89, 0xffff0000, v79
    v_sub_f32 v88, v88, v91
    v_sub_f32 v89, v89, v91
    v_fmac_f32 v104, v88, v88
    v_fmac_f32 v105, v89, v89
    v_lshlrev_b32 v88, 16, v80
    v_and_b32 v89, 0xffff0000, v80
    v_sub_f32 v88, v88, v91
    v_sub_f32 v89, v89, v91
    v_fmac_f32 v104, v88, v88
    v_fmac_f32 v105, v89, v89
    v_lshlrev_b32 v88, 16, v81
    v_and_b32 v89, 0xffff0000, v81
    v_sub_f32 v88, v88, v91
    v_sub_f32 v89, v89, v91
    v_fmac_f32 v104, v88, v88
    v_fmac_f32 v105, v89, v89
    v_lshlrev_b32 v88, 16, v82
    v_and_b32 v89, 0xffff0000, v82
    v_sub_f32 v88, v88, v91
    v_sub_f32 v89, v89, v91
    v_fmac_f32 v104, v88, v88
    v_fmac_f32 v105, v89, v89
    v_lshlrev_b32 v88, 16, v83
    v_and_b32 v89, 0xffff0000, v83
    v_sub_f32 v88, v88, v91
    v_sub_f32 v89, v89, v91
    v_fmac_f32 v104, v88, v88
    v_fmac_f32 v105, v89, v89
    v_lshlrev_b32 v88, 16, v84
    v_and_b32 v89, 0xffff0000, v84
    v_sub_f32 v88, v88, v91
    v_sub_f32 v89, v89, v91
    v_fmac_f32 v104, v88, v88
    v_fmac_f32 v105, v89, v89
    v_lshlrev_b32 v88, 16, v85
    v_and_b32 v89, 0xffff0000, v85
    v_sub_f32 v88, v88, v91
    v_sub_f32 v89, v89, v91
    v_fmac_f32 v104, v88, v88
    v_fmac_f32 v105, v89, v89
    v_lshlrev_b32 v88, 16, v86
    v_and_b32 v89, 0xffff0000, v86
    v_sub_f32 v88, v88, v91
    v_sub_f32 v89, v89, v91
    v_fmac_f32 v104, v88, v88
    v_fmac_f32 v105, v89, v89
    v_lshlrev_b32 v88, 16, v87
    v_and_b32 v89, 0xffff0000, v87
    v_sub_f32 v88, v88, v91
    v_sub_f32 v89, v89, v91
    v_fmac_f32 v104, v88, v88
    v_fmac_f32 v105, v89, v89
    v_add_f32 v102, v102, v103
    s_nop 1
    v_add_f32_dpp v102, v102, v102 quad_perm:[1,0,3,2] row_mask:0xf bank_mask:0xf
    s_nop 1
    v_add_f32_dpp v102, v102, v102 quad_perm:[2,3,0,1] row_mask:0xf bank_mask:0xf
    s_nop 1
    v_add_f32_dpp v102, v102, v102 row_half_mirror row_mask:0xf bank_mask:0xf
    v_mul_f32 v102, 0x3b124925, v102
    v_cvt_pk_bf16_f32 v102, v102, v102
    v_lshlrev_b32 v102, 16, v102
    v_add_f32 v102, 0x3727c5ac, v102
    v_cvt_pk_bf16_f32 v102, v102, v102
    v_lshlrev_b32 v102, 16, v102
    v_sqrt_f32 v102, v102
    s_nop 0
    v_cvt_pk_bf16_f32 v102, v102, v102
    v_lshlrev_b32 v102, 16, v102
    v_rcp_f32 v93, v102
    v_mov_b32 v94, s78
    v_mov_b32 v95, 0
    buffer_store_dwordx4 v[92:95], v101, s[68:71], s95 offen offset:0 sc1
    v_add_f32 v104, v104, v105
    s_nop 1
    v_add_f32_dpp v104, v104, v104 quad_perm:[1,0,3,2] row_mask:0xf bank_mask:0xf
    s_nop 1
    v_add_f32_dpp v104, v104, v104 quad_perm:[2,3,0,1] row_mask:0xf bank_mask:0xf
    s_nop 1
    v_add_f32_dpp v104, v104, v104 row_half_mirror row_mask:0xf bank_mask:0xf
    v_mul_f32 v104, 0x3b124925, v104
    v_cvt_pk_bf16_f32 v104, v104, v104
    v_lshlrev_b32 v104, 16, v104
    v_add_f32 v104, 0x3727c5ac, v104
    v_cvt_pk_bf16_f32 v104, v104, v104
    v_lshlrev_b32 v104, 16, v104
    v_sqrt_f32 v104, v104
    s_nop 0
    v_cvt_pk_bf16_f32 v104, v104, v104
    v_lshlrev_b32 v104, 16, v104
    v_rcp_f32 v97, v104
    v_mov_b32 v98, s78
    v_mov_b32 v99, 0
    buffer_store_dwordx4 v[96:99], v101, s[68:71], s95 offen offset:128 sc1
    s_cmp_lg_u32 s2, 0
    s_cbranch_scc1 L_h_end
    s_cmp_lg_u32 s72, 0
    s_cbranch_scc1 L_h_end
    v_lshlrev_b32 v2, 7, v1
    v_and_b32 v3, 31, v1
    v_lshlrev_b32 v3, 7, v3
    s_mov_b32 s86, 0
L_ep_spin:
    s_mov_b32 s90, 13107200
    buffer_load_dword v32, v2, s[68:71], s90 offen sc1
    s_mov_b32 s90, 13115392
    buffer_load_dword v33, v2, s[68:71], s90 offen sc1
    s_mov_b32 s90, 13123584
    buffer_load_dword v34, v2, s[68:71], s90 offen sc1
    s_mov_b32 s90, 13131776
    buffer_load_dword v35, v3, s[68:71], s90 offen sc1
    s_mov_b32 s90, 12845060
    buffer_load_dword v36, v2, s[68:71], s90 offen sc1
    s_mov_b32 s90, 12853252
    buffer_load_dword v37, v2, s[68:71], s90 offen sc1
    s_waitcnt vmcnt(0)
    v_xor_b32 v32, s78, v32
    v_xor_b32 v33, s78, v33
    v_xor_b32 v34, s78, v34
    v_xor_b32 v35, s78, v35
    v_xor_b32 v36, s78, v36
    v_xor_b32 v37, s78, v37
    v_or_b32 v32, v32, v33
    v_or_b32 v32, v32, v34
    v_or_b32 v32, v32, v35
    v_or_b32 v32, v32, v36
    v_or_b32 v32, v32, v37
    v_cmp_ne_u32 vcc, 0, v32
    s_add_u32 s86, s86, 1
    s_cmp_lt_u32 s86, 100000
    s_cbranch_scc0 L_ep_go
    s_cbranch_vccz L_ep_go
    s_sleep 32
    s_branch L_ep_spin
L_ep_go:
    s_mov_b32 s90, 13336576
    buffer_store_dword a224, v31, s[68:71], s90 offen sc1
L_h_end:
    s_endpgm
L_exit:
    s_endpgm
L_end_of_code:
.section .rodata,"a"
.p2align 6
.amdhsa_kernel parallel_sum__ssm_conv_h3__glu_gated_bilinear__prompt_kernel
  .amdhsa_next_free_vgpr 512
  .amdhsa_next_free_sgpr 102
  .amdhsa_accum_offset 256
  .amdhsa_group_segment_fixed_size 0
  .amdhsa_kernarg_size 104
  .amdhsa_user_sgpr_count 2
  .amdhsa_user_sgpr_kernarg_segment_ptr 1
  .amdhsa_system_sgpr_workgroup_id_x 1
  .amdhsa_float_denorm_mode_32 3
.end_amdhsa_kernel
```
